```python
import torch

def _softmax(x, axis=-1):
    return torch.softmax(x, dim=axis)

def _gelu(x):
    return torch.nn.functional.gelu(x, approximate='tanh')

def _silu(x):
    return torch.nn.functional.silu(x)

def _sigmoid(x):
    return torch.sigmoid(x)

def _layernorm(x, axis=-1, eps=1e-05):
    m = x.mean(dim=axis, keepdim=True)
    v = x.var(dim=axis, keepdim=True, unbiased=False)
    return (x - m) / torch.sqrt(v + eps)

def _scatter_add(tgt, idx, src, axis=0):
    return tgt.clone().index_add_(axis, idx, src)

def _segment_sum(src, seg, n):
    out = torch.zeros((n,) + src.shape[1:], dtype=src.dtype)
    return out.index_add_(0, seg, src)

def _pad(x, pw):
    flat = tuple((v for pair in reversed(pw) for v in pair))
    return torch.nn.functional.pad(x, flat)
kernel_name = 'adaLN_cond__grouped_kv_mqa__mixer_channel_mlp__prompt'

def setup_inputs():

    _w = lambda a: (lambda t: t.to(torch.bfloat16) if t.is_floating_point() else t)(torch.as_tensor(a))

    def _A_setup():
        B, S, D, H = (1, 2048, 640, 32)
        Dh = D // H
        return {'x': _w((lambda *s: torch.randn(*s, dtype=torch.bfloat16) * 0.05)(B, S, D)), 'wq': _w((lambda *s: torch.randn(*s, dtype=torch.bfloat16) * 0.05)(D, H * Dh)), 'wk': _w((lambda *s: torch.randn(*s, dtype=torch.bfloat16) * 0.05)(D, Dh)), 'wv': _w((lambda *s: torch.randn(*s, dtype=torch.bfloat16) * 0.05)(D, Dh)), 'wo': _w((lambda *s: torch.randn(*s, dtype=torch.bfloat16) * 0.05)(H * Dh, D))}
    _A_in = _A_setup()

    def _B_setup():
        B, S, D, F = (1, 2048, 640, 1728)
        return {'x': _w((lambda *s: torch.randn(*s, dtype=torch.bfloat16) * 0.05)(B, S, D)), 'w1': _w((lambda *s: torch.randn(*s, dtype=torch.bfloat16) * 3.2)(D, F) * D ** (-0.5)), 'b1': _w((lambda *s: torch.randn(*s, dtype=torch.bfloat16) * 0.8)(F)), 'w2': _w((lambda *s: torch.randn(*s, dtype=torch.bfloat16) * 3.2)(F, D) * F ** (-0.5)), 'b2': _w((lambda *s: torch.randn(*s, dtype=torch.bfloat16) * 3.2)(D))}
    _B_in = _B_setup()
    return {'A_x': _A_in['x'], 'A_wq': _A_in['wq'], 'A_wk': _A_in['wk'], 'A_wv': _A_in['wv'], 'A_wo': _A_in['wo'], 'B_x': _B_in['x'], 'B_w1': _B_in['w1'], 'B_b1': _B_in['b1'], 'B_w2': _B_in['w2'], 'B_b2': _B_in['b2'], 'c': _w((lambda *s: torch.randn(*s, dtype=torch.bfloat16) * 0.1)(1, 640) * 8.0), 'w_mod': _w((lambda *s: torch.randn(*s, dtype=torch.bfloat16) * 0.1)(640, 6 * 640) * 640 ** (-0.5) * 8.0)}

def reference(A_x, A_wq, A_wk, A_wv, A_wo, B_x, B_w1, B_b1, B_w2, B_b2, c, w_mod):

    def _A_ref(x, wq, wk, wv, wo):
        B, S, D = x.shape
        H = 32
        Dh = D // H
        q = (lambda x, *d: x.permute(*d))((x @ wq).reshape(B, S, H, Dh), 0, 2, 1, 3)
        k = x @ wk
        v = x @ wv
        scores = torch.einsum('bhqd,bkd->bhqk', q, k) * Dh ** (-0.5)
        p = _softmax(scores, axis=-1)
        o = torch.einsum('bhqk,bkd->bhqd', p, v)
        return (lambda x, *d: x.permute(*d))(o, 0, 2, 1, 3).reshape(B, S, H * Dh) @ wo

    def _B_ref(x, w1, b1, w2, b2):
        y = _layernorm(x, axis=-1)
        h = _gelu(torch.einsum('bsd,df->bsf', y, w1) + b1)
        return torch.einsum('bsf,fd->bsd', h, w2) + b2
    x = A_x
    mod = (_silu(c) @ w_mod).reshape(c.shape[0], 6, 1, -1)
    sa, ca, ga, sb, cb, gb = (mod[:, 0].clone(), mod[:, 1].clone(), mod[:, 2].clone(), mod[:, 3].clone(), mod[:, 4].clone(), mod[:, 5].clone())
    h = _layernorm(x, axis=-1) * (1 + ca) + sa
    x = x + ga * _A_ref(h, A_wq, A_wk, A_wv, A_wo)
    h = _layernorm(x, axis=-1) * (1 + cb) + sb
    x = x + gb * _B_ref(h, B_w1, B_b1, B_w2, B_b2)
    return x
```

```asm
; @launch grid=(256,1,1) block=(512,1,1) lds=163840
.amdgcn_target "amdgcn-amd-amdhsa--gfx950"
.text
.globl adaLN_cond__grouped_kv_mqa__mixer_channel_mlp__prompt_kernel
.p2align 8
.type adaLN_cond__grouped_kv_mqa__mixer_channel_mlp__prompt_kernel,@function
adaLN_cond__grouped_kv_mqa__mixer_channel_mlp__prompt_kernel:
    s_cmp_ge_u32 s2, 256
    s_cbranch_scc1 L_adaLN_cond__grouped_kv_mqa__mixer_channel_mlp__prompt_kernel_end
    s_load_dwordx16 s[36:51], s[0:1], 0
    s_load_dwordx8 s[52:59], s[0:1], 64
    s_load_dwordx4 s[60:63], s[0:1], 96
    s_load_dwordx2 s[64:65], s[0:1], 112
    v_and_b32 v1, 63, v0
    v_lshrrev_b32 v2, 6, v0
    s_and_b32 s66, s2, 7
    v_readfirstlane_b32 s3, v2
    s_lshr_b32 s67, s2, 3
    v_lshlrev_b32 v2, 4, v1
    v_and_b32 v3, 31, v1
    v_lshrrev_b32 v4, 5, v1
    s_waitcnt lgkmcnt(0)
    s_load_dwordx2 s[76:77], s[64:65], 29184
    s_mov_b32 s4, s64
    s_mov_b32 s5, s65
    s_mov_b32 s6, 23068672
    s_mov_b32 s7, 0x20000
    s_mov_b32 s8, s38
    s_mov_b32 s9, s39
    s_mov_b32 s10, 819200
    s_mov_b32 s11, 0x20000
    s_mov_b32 s69, 0
    s_cmp_lt_u32 s2, 144
    s_cbranch_scc1 L_p0_nt
    s_sub_u32 s20, s67, 18
    s_lshl_b32 s20, s20, 3
    s_add_u32 s20, s20, s3
    s_lshl_b32 s20, s20, 13
    v_lshlrev_b32 v5, 7, v1
    buffer_load_dword v253, v5, s[8:11], s20 offen
    buffer_load_dword v253, v5, s[8:11], s20 offen offset:64
L_p0_nt:
    s_sub_u32 s68, s2, 80
    s_mov_b32 s70, s2
    s_cmp_lt_u32 s68, 64
    s_cbranch_scc1 L_p0_x
    s_cmp_lt_u32 s2, 240
    s_cbranch_scc1 L_p0_q
    s_mov_b32 s11, 0x20000
    s_cmp_eq_u32 s3, 0
    s_cselect_b32 s8, s64, s64
    s_cselect_b32 s9, s65, s65
    s_cselect_b32 s10, 23068672, 0
    s_cmp_eq_u32 s3, 1
    s_cselect_b32 s8, s44, s8
    s_cselect_b32 s9, s45, s9
    s_cselect_b32 s10, 819200, s10
    s_cmp_eq_u32 s3, 2
    s_cselect_b32 s8, s48, s8
    s_cselect_b32 s9, s49, s9
    s_cselect_b32 s10, 2211840, s10
    s_cmp_eq_u32 s3, 3
    s_cselect_b32 s8, s52, s8
    s_cselect_b32 s9, s53, s9
    s_cselect_b32 s10, 2211840, s10
    s_cmp_eq_u32 s3, 4
    s_cselect_b32 s8, s60, s8
    s_cselect_b32 s9, s61, s9
    s_cselect_b32 s10, 2621440, s10
    s_cmp_eq_u32 s3, 5
    s_cselect_b32 s8, s50, s8
    s_cselect_b32 s9, s51, s9
    s_cselect_b32 s10, 3456, s10
    s_cmp_eq_u32 s3, 6
    s_cselect_b32 s8, s54, s8
    s_cselect_b32 s9, s55, s9
    s_cselect_b32 s10, 1280, s10
    s_cmp_eq_u32 s3, 7
    s_cselect_b32 s8, s62, s8
    s_cselect_b32 s9, s63, s9
    s_cselect_b32 s10, 256, s10
    s_cmp_eq_u32 s3, 0
    s_cselect_b32 s20, 19, 16
    v_lshlrev_b32 v5, s20, v1
    s_getpc_b64 s[78:79]
L_pc0:
    v_lshlrev_b32 v6, 7, v0
    v_min_u32 v6, L_code_end-L_pc0-4, v6
    global_load_dword v254, v6, s[78:79]
    buffer_load_dword v255, v5, s[8:11], 0 offen
    s_waitcnt lgkmcnt(0)
    s_add_u32 s76, s76, 1
    s_addc_u32 s77, s77, 0
    s_branch L_p0_done
L_p0_q:
    s_mov_b32 s12, s56
    s_mov_b32 s13, s57
    s_mov_b32 s14, 1280
    s_mov_b32 s15, 0x20000
    s_mov_b32 s8, s58
    s_mov_b32 s9, s59
    s_mov_b32 s10, 4915200
    s_mov_b32 s11, 0x20000
    s_and_b32 s20, s70, 3
    s_lshr_b32 s21, s70, 2
    s_mul_i32 s22, s20, 320
    v_lshlrev_b32 v9, 2, v0
    buffer_load_dword v12, v9, s[12:15], s22 offen
    s_mov_b32 s25, 7680
    v_lshrrev_b32 v6, 3, v1
    v_bfe_u32 v7, v1, 4, 1
    v_lshlrev_b32 v7, 2, v7
    v_and_b32 v5, 7, v1
    v_xor_b32 v5, v5, v7
    v_lshlrev_b32 v5, 4, v5
    v_mad_u32_u24 v5, v6, s25, v5
    s_lshl_b32 s24, s21, 7
    v_add_u32 v5, s24, v5
    s_mul_i32 s27, s20, 1228800
    s_mul_i32 s26, s3, 61440
    s_add_u32 s27, s27, s26
    s_lshl_b32 s28, s3, 10
    s_add_u32 s28, s28, 131072
    s_mov_b32 m0, s28
    s_add_u32 s26, s27, 491520
    buffer_load_dwordx4 v5, s[8:11], s27 offen lds
    s_add_u32 m0, s28, 8192
    s_add_u32 s27, s27, 983040
    buffer_load_dwordx4 v5, s[8:11], s26 offen lds
    s_add_u32 m0, s28, 16384
    s_cmp_ge_u32 s3, 4
    s_cselect_b32 s27, 4915200, s27
    s_cselect_b32 s26, 152576, m0
    s_mov_b32 m0, s26
    s_nop 0
    buffer_load_dwordx4 v5, s[8:11], s27 offen lds
L_p0_x2:
    s_cmp_lg_u32 s70, s2
    s_cbranch_scc1 L_p0_x3
    s_waitcnt lgkmcnt(0)
    s_add_u32 s76, s76, 1
    s_addc_u32 s77, s77, 0
L_p0_x3:
    s_waitcnt vmcnt(3)
    v_lshlrev_b32 v10, 16, v12
    v_and_b32 v11, 0xffff0000, v12
    v_mul_f32 v14, 0xbfb8aa3b, v10
    v_mul_f32 v15, 0xbfb8aa3b, v11
    v_exp_f32 v14, v14
    v_exp_f32 v15, v15
    v_add_u32 v9, 151552, v9
    v_add_f32 v14, 1.0, v14
    v_add_f32 v15, 1.0, v15
    v_rcp_f32 v14, v14
    v_rcp_f32 v15, v15
    v_cmp_gt_u32 vcc, 80, v0
    v_mul_f32 v10, v10, v14
    v_mul_f32 v11, v11, v15
    v_cvt_pk_bf16_f32 v10, v10, v11
    s_and_saveexec_b64 s[26:27], vcc
    ds_write_b32 v9, v10
    s_mov_b64 exec, -1
    v_bfe_u32 v10, v1, 2, 2
    v_lshl_add_u32 v11, v4, 3, v10
    v_mul_u32_u24 v13, 128, v11
    v_lshrrev_b32 v10, 1, v10
    v_xor_b32 v10, s3, v10
    v_lshl_add_u32 v13, v10, 6, v13
    v_bfe_u32 v10, v1, 4, 1
    v_lshl_add_u32 v13, v10, 5, v13
    v_and_b32 v10, 1, v1
    v_lshl_add_u32 v13, v10, 4, v13
    v_bfe_u32 v10, v1, 1, 1
    v_lshl_add_u32 v13, v10, 3, v13
    v_add_u32 v13, 131072, v13
    v_lshlrev_b32 v14, 4, v4
    v_add_u32 v14, 151552, v14
    s_waitcnt vmcnt(0) lgkmcnt(0)
    s_barrier
    s_cmp_ge_u32 s3, 2
    s_cbranch_scc1 L_p0_qb
    ds_read_b128 v[96:99], v14 offset:0
    ds_read_b64_tr_b16 v[100:101], v13 offset:0
    ds_read_b64_tr_b16 v[102:103], v13 offset:512
    ds_read_b128 v[104:107], v14 offset:32
    ds_read_b64_tr_b16 v[108:109], v13 offset:2048
    ds_read_b64_tr_b16 v[110:111], v13 offset:2560
    ds_read_b128 v[112:115], v14 offset:64
    ds_read_b64_tr_b16 v[116:117], v13 offset:4096
    ds_read_b64_tr_b16 v[118:119], v13 offset:4608
    ds_read_b128 v[120:123], v14 offset:96
    ds_read_b64_tr_b16 v[124:125], v13 offset:6144
    ds_read_b64_tr_b16 v[126:127], v13 offset:6656
    ds_read_b128 v[128:131], v14 offset:128
    ds_read_b64_tr_b16 v[132:133], v13 offset:8192
    ds_read_b64_tr_b16 v[134:135], v13 offset:8704
    s_waitcnt lgkmcnt(0)
    v_mfma_f32_32x32x16_bf16 v[176:191], v[96:99], v[100:103], 0
    v_mfma_f32_32x32x16_bf16 v[176:191], v[104:107], v[108:111], v[176:191]
    v_mfma_f32_32x32x16_bf16 v[176:191], v[112:115], v[116:119], v[176:191]
    v_mfma_f32_32x32x16_bf16 v[176:191], v[120:123], v[124:127], v[176:191]
    v_mfma_f32_32x32x16_bf16 v[176:191], v[128:131], v[132:135], v[176:191]
    ds_read_b128 v[136:139], v14 offset:160
    ds_read_b64_tr_b16 v[140:141], v13 offset:10240
    ds_read_b64_tr_b16 v[142:143], v13 offset:10752
    ds_read_b128 v[144:147], v14 offset:192
    ds_read_b64_tr_b16 v[148:149], v13 offset:12288
    ds_read_b64_tr_b16 v[150:151], v13 offset:12800
    ds_read_b128 v[152:155], v14 offset:224
    ds_read_b64_tr_b16 v[156:157], v13 offset:14336
    ds_read_b64_tr_b16 v[158:159], v13 offset:14848
    ds_read_b128 v[160:163], v14 offset:256
    ds_read_b64_tr_b16 v[164:165], v13 offset:16384
    ds_read_b64_tr_b16 v[166:167], v13 offset:16896
    ds_read_b128 v[168:171], v14 offset:288
    ds_read_b64_tr_b16 v[172:173], v13 offset:18432
    ds_read_b64_tr_b16 v[174:175], v13 offset:18944
    s_waitcnt lgkmcnt(0)
    v_mfma_f32_32x32x16_bf16 v[176:191], v[136:139], v[140:143], v[176:191]
    v_mfma_f32_32x32x16_bf16 v[176:191], v[144:147], v[148:151], v[176:191]
    v_mfma_f32_32x32x16_bf16 v[176:191], v[152:155], v[156:159], v[176:191]
    v_mfma_f32_32x32x16_bf16 v[176:191], v[160:163], v[164:167], v[176:191]
    v_mfma_f32_32x32x16_bf16 v[176:191], v[168:171], v[172:175], v[176:191]
    v_and_b32 v10, 19, v3
    v_bfe_u32 v11, v3, 2, 1
    v_lshl_add_u32 v10, v11, 3, v10
    v_bfe_u32 v11, v3, 3, 1
    v_lshl_add_u32 v10, v11, 2, v10
    v_lshlrev_b32 v10, 2, v10
    s_and_b32 s20, s70, 3
    s_mul_i32 s24, s20, 15360
    s_lshr_b32 s25, s70, 2
    s_lshl_b32 s25, s25, 8
    s_add_u32 s24, s24, s25
    s_lshl_b32 s25, s3, 7
    s_add_u32 s24, s24, s25
    s_add_u32 s24, s24, 524288
    s_lshl_b32 s25, s70, 1
    s_add_u32 s25, s25, s3
    s_add_u32 s25, s25, 1536
    s_mov_b32 exec_hi, 0
    buffer_store_dword v176, v10, s[4:7], s24 offen sc1
    s_waitcnt vmcnt(0)
    s_mov_b64 exec, 0xff
    s_lshl_b32 s74, s25, 7
    s_add_u32 s74, s74, 262144
    v_mov_b32 v14, s76
    v_mov_b32 v15, s77
    v_mov_b32 v16, 0
    v_mov_b32 v17, 0
    buffer_store_dwordx4 v[14:17], v2, s[4:7], s74 offen sc1
    s_mov_b64 exec, -1
L_p0_qb:
    s_cmp_ge_u32 s2, 208
    s_cbranch_scc1 L_p0_done
    s_cmp_lg_u32 s70, s2
    s_cbranch_scc1 L_p0_done
    s_barrier
    s_cmp_lt_u32 s2, 80
    s_cbranch_scc1 L_p0_done
    s_sub_u32 s70, s2, 64
    s_branch L_p0_q
L_p0_x:
    s_mov_b32 s12, s36
    s_mov_b32 s13, s37
    s_mov_b32 s14, 2621440
    s_mov_b32 s15, 0x20000
    s_mul_i32 s24, s68, 40960
    s_mul_i32 s25, s3, 5120
    s_add_u32 s24, s24, s25
    s_add_u32 s25, s25, 81920
    s_lshl_b32 s26, s3, 2
    v_lshrrev_b32 v6, 4, v1
    v_and_b32 v7, 15, v1
    v_add_u32 v10, 0, v6
    v_mul_u32_u24 v11, 205, v10
    v_lshrrev_b32 v11, 10, v11
    v_add_u32 v11, s26, v11
    v_xor_b32 v11, v11, v7
    v_and_b32 v11, 15, v11
    v_lshlrev_b32 v11, 4, v11
    s_add_u32 m0, s25, 0
    v_lshl_add_u32 v16, v10, 8, v11
    buffer_load_dwordx4 v16, s[12:15], s24 offen lds
    v_add_u32 v10, 4, v6
    v_mul_u32_u24 v11, 205, v10
    v_lshrrev_b32 v11, 10, v11
    v_add_u32 v11, s26, v11
    v_xor_b32 v11, v11, v7
    v_and_b32 v11, 15, v11
    v_lshlrev_b32 v11, 4, v11
    s_add_u32 m0, s25, 1024
    v_lshl_add_u32 v17, v10, 8, v11
    buffer_load_dwordx4 v17, s[12:15], s24 offen lds
    v_add_u32 v10, 8, v6
    v_mul_u32_u24 v11, 205, v10
    v_lshrrev_b32 v11, 10, v11
    v_add_u32 v11, s26, v11
    v_xor_b32 v11, v11, v7
    v_and_b32 v11, 15, v11
    v_lshlrev_b32 v11, 4, v11
    s_add_u32 m0, s25, 2048
    v_lshl_add_u32 v18, v10, 8, v11
    buffer_load_dwordx4 v18, s[12:15], s24 offen lds
    v_add_u32 v10, 12, v6
    v_mul_u32_u24 v11, 205, v10
    v_lshrrev_b32 v11, 10, v11
    v_add_u32 v11, s26, v11
    v_xor_b32 v11, v11, v7
    v_and_b32 v11, 15, v11
    v_lshlrev_b32 v11, 4, v11
    s_add_u32 m0, s25, 3072
    v_lshl_add_u32 v19, v10, 8, v11
    buffer_load_dwordx4 v19, s[12:15], s24 offen lds
    v_add_u32 v10, 16, v6
    v_mul_u32_u24 v11, 205, v10
    v_lshrrev_b32 v11, 10, v11
    v_add_u32 v11, s26, v11
    v_xor_b32 v11, v11, v7
    v_and_b32 v11, 15, v11
    v_lshlrev_b32 v11, 4, v11
    s_add_u32 m0, s25, 4096
    v_lshl_add_u32 v16, v10, 8, v11
    buffer_load_dwordx4 v16, s[12:15], s24 offen lds
    s_waitcnt lgkmcnt(0)
    s_add_u32 s76, s76, 1
    s_addc_u32 s77, s77, 0
    s_mul_i32 s24, s3, 10
    v_add_u32 v8, s24, v4
    v_mul_u32_u24 v9, 1280, v3
    v_add_u32 v9, 81920, v9
    v_lshlrev_b32 v6, 5, v3
    v_add_u32 v6, 122880, v6
    s_lshl_b32 s23, s3, 2
    v_add_u32 v7, s23, v6
    s_waitcnt vmcnt(0)
    s_barrier
    v_add_u32 v80, 0, v8
    v_xor_b32 v81, v80, v3
    v_and_b32 v81, 15, v81
    v_and_b32 v80, 0x70, v80
    v_add_lshl_u32 v80, v80, v81, 4
    v_add_u32 v80, v80, v9
    ds_read_b128 v[10:13], v80
    v_add_u32 v80, 2, v8
    v_xor_b32 v81, v80, v3
    v_and_b32 v81, 15, v81
    v_and_b32 v80, 0x70, v80
    v_add_lshl_u32 v80, v80, v81, 4
    v_add_u32 v80, v80, v9
    ds_read_b128 v[14:17], v80
    v_add_u32 v80, 4, v8
    v_xor_b32 v81, v80, v3
    v_and_b32 v81, 15, v81
    v_and_b32 v80, 0x70, v80
    v_add_lshl_u32 v80, v80, v81, 4
    v_add_u32 v80, v80, v9
    ds_read_b128 v[18:21], v80
    v_add_u32 v80, 6, v8
    v_xor_b32 v81, v80, v3
    v_and_b32 v81, 15, v81
    v_and_b32 v80, 0x70, v80
    v_add_lshl_u32 v80, v80, v81, 4
    v_add_u32 v80, v80, v9
    ds_read_b128 v[22:25], v80
    v_add_u32 v80, 8, v8
    v_xor_b32 v81, v80, v3
    v_and_b32 v81, 15, v81
    v_and_b32 v80, 0x70, v80
    v_add_lshl_u32 v80, v80, v81, 4
    v_add_u32 v80, v80, v9
    ds_read_b128 v[26:29], v80
    v_mov_b32 v70, 163776
    v_mov_b32 v71, 0
    ds_write_b32 v70, v71
    s_waitcnt lgkmcnt(0)
    v_lshlrev_b32 v30, 16, v10
    v_and_b32 v31, 0xffff0000, v10
    v_lshlrev_b32 v32, 16, v11
    v_and_b32 v33, 0xffff0000, v11
    v_lshlrev_b32 v34, 16, v12
    v_and_b32 v35, 0xffff0000, v12
    v_lshlrev_b32 v36, 16, v13
    v_and_b32 v37, 0xffff0000, v13
    v_lshlrev_b32 v38, 16, v14
    v_and_b32 v39, 0xffff0000, v14
    v_lshlrev_b32 v40, 16, v15
    v_and_b32 v41, 0xffff0000, v15
    v_lshlrev_b32 v42, 16, v16
    v_and_b32 v43, 0xffff0000, v16
    v_lshlrev_b32 v44, 16, v17
    v_and_b32 v45, 0xffff0000, v17
    v_lshlrev_b32 v46, 16, v18
    v_and_b32 v47, 0xffff0000, v18
    v_lshlrev_b32 v48, 16, v19
    v_and_b32 v49, 0xffff0000, v19
    v_lshlrev_b32 v50, 16, v20
    v_and_b32 v51, 0xffff0000, v20
    v_lshlrev_b32 v52, 16, v21
    v_and_b32 v53, 0xffff0000, v21
    v_lshlrev_b32 v54, 16, v22
    v_and_b32 v55, 0xffff0000, v22
    v_lshlrev_b32 v56, 16, v23
    v_and_b32 v57, 0xffff0000, v23
    v_lshlrev_b32 v58, 16, v24
    v_and_b32 v59, 0xffff0000, v24
    v_lshlrev_b32 v60, 16, v25
    v_and_b32 v61, 0xffff0000, v25
    v_lshlrev_b32 v62, 16, v26
    v_and_b32 v63, 0xffff0000, v26
    v_lshlrev_b32 v64, 16, v27
    v_and_b32 v65, 0xffff0000, v27
    v_lshlrev_b32 v66, 16, v28
    v_and_b32 v67, 0xffff0000, v28
    v_lshlrev_b32 v68, 16, v29
    v_and_b32 v69, 0xffff0000, v29
    v_add_f32 v70, v30, v34
    v_add_f32 v71, v31, v35
    v_add_f32 v72, v32, v36
    v_add_f32 v73, v33, v37
    v_add_f32 v70, v70, v38
    v_add_f32 v71, v71, v39
    v_add_f32 v72, v72, v40
    v_add_f32 v73, v73, v41
    v_add_f32 v70, v70, v42
    v_add_f32 v71, v71, v43
    v_add_f32 v72, v72, v44
    v_add_f32 v73, v73, v45
    v_add_f32 v70, v70, v46
    v_add_f32 v71, v71, v47
    v_add_f32 v72, v72, v48
    v_add_f32 v73, v73, v49
    v_add_f32 v70, v70, v50
    v_add_f32 v71, v71, v51
    v_add_f32 v72, v72, v52
    v_add_f32 v73, v73, v53
    v_add_f32 v70, v70, v54
    v_add_f32 v71, v71, v55
    v_add_f32 v72, v72, v56
    v_add_f32 v73, v73, v57
    v_add_f32 v70, v70, v58
    v_add_f32 v71, v71, v59
    v_add_f32 v72, v72, v60
    v_add_f32 v73, v73, v61
    v_add_f32 v70, v70, v62
    v_add_f32 v71, v71, v63
    v_add_f32 v72, v72, v64
    v_add_f32 v73, v73, v65
    v_add_f32 v70, v70, v66
    v_add_f32 v71, v71, v67
    v_add_f32 v72, v72, v68
    v_add_f32 v73, v73, v69
    v_add_f32 v70, v70, v71
    v_add_f32 v72, v72, v73
    v_add_f32 v70, v70, v72
    v_mov_b32 v71, v70
    s_nop 1
    v_permlane32_swap_b32 v70, v71
    v_add_f32 v70, v70, v71
    ds_write_b32 v7, v70
    s_waitcnt lgkmcnt(0)
    s_barrier
    ds_read_b128 v[72:75], v6
    ds_read_b128 v[76:79], v6 offset:16
    s_waitcnt lgkmcnt(0)
    v_add_f32 v72, v72, v73
    v_add_f32 v74, v74, v75
    v_add_f32 v76, v76, v77
    v_add_f32 v78, v78, v79
    v_add_f32 v72, v72, v74
    v_add_f32 v76, v76, v78
    v_add_f32 v72, v72, v76
    v_mul_f32 v72, 0x3acccccd, v72
    v_sub_f32 v30, v30, v72
    v_sub_f32 v31, v31, v72
    v_sub_f32 v32, v32, v72
    v_sub_f32 v33, v33, v72
    v_sub_f32 v34, v34, v72
    v_sub_f32 v35, v35, v72
    v_sub_f32 v36, v36, v72
    v_sub_f32 v37, v37, v72
    v_sub_f32 v38, v38, v72
    v_sub_f32 v39, v39, v72
    v_sub_f32 v40, v40, v72
    v_sub_f32 v41, v41, v72
    v_sub_f32 v42, v42, v72
    v_sub_f32 v43, v43, v72
    v_sub_f32 v44, v44, v72
    v_sub_f32 v45, v45, v72
    v_sub_f32 v46, v46, v72
    v_sub_f32 v47, v47, v72
    v_sub_f32 v48, v48, v72
    v_sub_f32 v49, v49, v72
    v_sub_f32 v50, v50, v72
    v_sub_f32 v51, v51, v72
    v_sub_f32 v52, v52, v72
    v_sub_f32 v53, v53, v72
    v_sub_f32 v54, v54, v72
    v_sub_f32 v55, v55, v72
    v_sub_f32 v56, v56, v72
    v_sub_f32 v57, v57, v72
    v_sub_f32 v58, v58, v72
    v_sub_f32 v59, v59, v72
    v_sub_f32 v60, v60, v72
    v_sub_f32 v61, v61, v72
    v_sub_f32 v62, v62, v72
    v_sub_f32 v63, v63, v72
    v_sub_f32 v64, v64, v72
    v_sub_f32 v65, v65, v72
    v_sub_f32 v66, v66, v72
    v_sub_f32 v67, v67, v72
    v_sub_f32 v68, v68, v72
    v_sub_f32 v69, v69, v72
    v_mul_f32 v70, v30, v30
    v_mul_f32 v71, v31, v31
    v_mul_f32 v74, v32, v32
    v_mul_f32 v73, v33, v33
    v_fmac_f32 v70, v34, v34
    v_fmac_f32 v71, v35, v35
    v_fmac_f32 v74, v36, v36
    v_fmac_f32 v73, v37, v37
    v_fmac_f32 v70, v38, v38
    v_fmac_f32 v71, v39, v39
    v_fmac_f32 v74, v40, v40
    v_fmac_f32 v73, v41, v41
    v_fmac_f32 v70, v42, v42
    v_fmac_f32 v71, v43, v43
    v_fmac_f32 v74, v44, v44
    v_fmac_f32 v73, v45, v45
    v_fmac_f32 v70, v46, v46
    v_fmac_f32 v71, v47, v47
    v_fmac_f32 v74, v48, v48
    v_fmac_f32 v73, v49, v49
    v_fmac_f32 v70, v50, v50
    v_fmac_f32 v71, v51, v51
    v_fmac_f32 v74, v52, v52
    v_fmac_f32 v73, v53, v53
    v_fmac_f32 v70, v54, v54
    v_fmac_f32 v71, v55, v55
    v_fmac_f32 v74, v56, v56
    v_fmac_f32 v73, v57, v57
    v_fmac_f32 v70, v58, v58
    v_fmac_f32 v71, v59, v59
    v_fmac_f32 v74, v60, v60
    v_fmac_f32 v73, v61, v61
    v_fmac_f32 v70, v62, v62
    v_fmac_f32 v71, v63, v63
    v_fmac_f32 v74, v64, v64
    v_fmac_f32 v73, v65, v65
    v_fmac_f32 v70, v66, v66
    v_fmac_f32 v71, v67, v67
    v_fmac_f32 v74, v68, v68
    v_fmac_f32 v73, v69, v69
    v_add_f32 v70, v70, v71
    v_add_f32 v74, v74, v73
    v_add_f32 v70, v70, v74
    v_mov_b32 v71, v70
    s_nop 1
    v_permlane32_swap_b32 v70, v71
    v_add_f32 v70, v70, v71
    ds_write_b32 v7, v70 offset:1024
    s_waitcnt lgkmcnt(0)
    s_barrier
    ds_read_b128 v[72:75], v6 offset:1024
    ds_read_b128 v[76:79], v6 offset:1040
    s_waitcnt lgkmcnt(0)
    v_add_f32 v72, v72, v73
    v_add_f32 v74, v74, v75
    v_add_f32 v76, v76, v77
    v_add_f32 v78, v78, v79
    v_add_f32 v72, v72, v74
    v_add_f32 v76, v76, v78
    v_add_f32 v72, v72, v76
    v_mov_b32 v73, 0x3727c5ac
    v_fmac_f32 v73, 0x3acccccd, v72
    v_rsq_f32 v73, v73
    s_nop 0
    v_mul_f32 v30, v30, v73
    v_mul_f32 v31, v31, v73
    v_mul_f32 v32, v32, v73
    v_mul_f32 v33, v33, v73
    v_mul_f32 v34, v34, v73
    v_mul_f32 v35, v35, v73
    v_mul_f32 v36, v36, v73
    v_mul_f32 v37, v37, v73
    v_mul_f32 v38, v38, v73
    v_mul_f32 v39, v39, v73
    v_mul_f32 v40, v40, v73
    v_mul_f32 v41, v41, v73
    v_mul_f32 v42, v42, v73
    v_mul_f32 v43, v43, v73
    v_mul_f32 v44, v44, v73
    v_mul_f32 v45, v45, v73
    v_mul_f32 v46, v46, v73
    v_mul_f32 v47, v47, v73
    v_mul_f32 v48, v48, v73
    v_mul_f32 v49, v49, v73
    v_mul_f32 v50, v50, v73
    v_mul_f32 v51, v51, v73
    v_mul_f32 v52, v52, v73
    v_mul_f32 v53, v53, v73
    v_mul_f32 v54, v54, v73
    v_mul_f32 v55, v55, v73
    v_mul_f32 v56, v56, v73
    v_mul_f32 v57, v57, v73
    v_mul_f32 v58, v58, v73
    v_mul_f32 v59, v59, v73
    v_mul_f32 v60, v60, v73
    v_mul_f32 v61, v61, v73
    v_mul_f32 v62, v62, v73
    v_mul_f32 v63, v63, v73
    v_mul_f32 v64, v64, v73
    v_mul_f32 v65, v65, v73
    v_mul_f32 v66, v66, v73
    v_mul_f32 v67, v67, v73
    v_mul_f32 v68, v68, v73
    v_mul_f32 v69, v69, v73
L_p0_ln2:
    v_min_u32 v8, 39, v1
    v_cmp_lt_u32 vcc, 19, v8
    v_subrev_u32 v9, 20, v8
    v_min_u32 v9, v8, v9
    v_lshlrev_b32 v9, 4, v9
    v_mov_b32 v10, 2560
    v_cndmask_b32 v10, 0, v10, vcc
    v_add_u32 v9, v9, v10
    v_mov_b32 v5, 1.0
    v_cndmask_b32 v5, 0, v5, vcc
    s_mul_i32 s27, s3, 320
    s_add_u32 s27, s27, 524288
    s_mul_i32 s25, s3, 640
    s_add_u32 s25, s25, 124928
    v_lshl_add_u32 v6, v8, 4, s25
    v_lshl_add_u32 v8, v4, 5, s25
    s_mov_b32 s26, 0xffff0000
    s_mul_i32 s24, s68, 40960
    s_mul_i32 s25, s3, 5120
    s_add_u32 s24, s24, s25
    s_add_u32 s24, s24, 2097152
    s_cmp_lt_u32 s3, 5
    s_cbranch_scc1 L_p0x_go
    s_sub_u32 s28, s3, 5
    s_lshl_b32 s28, s28, 6
    v_add_u32 v80, s28, v1
    v_min_u32 v80, 159, v80
    v_add_u32 v80, 1536, v80
    v_lshlrev_b32 v80, 7, v80
    s_mov_b32 s74, 0
    s_mov_b32 s75, 262144
L_p0x_poll:
    buffer_load_dwordx2 v[82:83], v80, s[4:7], s75 offen sc1
    s_add_u32 s74, s74, 1
    s_waitcnt vmcnt(0)
    v_cmp_ne_u64 vcc, s[76:77], v[82:83]
    s_cmp_gt_u32 s74, 400000
    s_cbranch_scc1 L_p0x_go
    s_nop 2
    s_cbranch_vccz L_p0x_go
    s_sleep 1
    s_branch L_p0x_poll
L_p0x_go:
    s_barrier
    buffer_load_dwordx4 v[12:15], v9, s[4:7], s27 offen sc1
    s_add_u32 s27, s27, 15360
    buffer_load_dwordx4 v[16:19], v9, s[4:7], s27 offen sc1
    s_add_u32 s27, s27, 15360
    buffer_load_dwordx4 v[20:23], v9, s[4:7], s27 offen sc1
    s_add_u32 s27, s27, 15360
    buffer_load_dwordx4 v[24:27], v9, s[4:7], s27 offen sc1
    s_add_u32 s27, s27, 15360
    s_waitcnt vmcnt(0)
    v_pk_add_f32 v[12:13], v[12:13], v[16:17]
    v_pk_add_f32 v[20:21], v[20:21], v[24:25]
    v_pk_add_f32 v[12:13], v[12:13], v[20:21]
    v_cvt_pk_bf16_f32 v28, v12, v13
    v_lshlrev_b32 v12, 16, v28
    v_and_b32 v13, s26, v28
    v_add_f32 v12, v12, v5
    v_add_f32 v13, v13, v5
    v_cvt_pk_bf16_f32 v28, v12, v13
    v_lshlrev_b32 v12, 16, v28
    v_and_b32 v13, s26, v28
    v_pk_add_f32 v[14:15], v[14:15], v[18:19]
    v_pk_add_f32 v[22:23], v[22:23], v[26:27]
    v_pk_add_f32 v[14:15], v[14:15], v[22:23]
    v_cvt_pk_bf16_f32 v28, v14, v15
    v_lshlrev_b32 v14, 16, v28
    v_and_b32 v15, s26, v28
    v_add_f32 v14, v14, v5
    v_add_f32 v15, v15, v5
    v_cvt_pk_bf16_f32 v28, v14, v15
    v_lshlrev_b32 v14, 16, v28
    v_and_b32 v15, s26, v28
    ds_write_b128 v6, v[12:15]
    s_waitcnt lgkmcnt(0)
    ds_read_b128 v[124:127], v8 offset:320
    ds_read_b128 v[128:131], v8 offset:336
    ds_read_b128 v[132:135], v8 offset:0
    ds_read_b128 v[136:139], v8 offset:16
    ds_read_b128 v[140:143], v8 offset:384
    ds_read_b128 v[144:147], v8 offset:400
    ds_read_b128 v[148:151], v8 offset:64
    ds_read_b128 v[152:155], v8 offset:80
    ds_read_b128 v[156:159], v8 offset:448
    ds_read_b128 v[160:163], v8 offset:464
    ds_read_b128 v[164:167], v8 offset:128
    ds_read_b128 v[168:171], v8 offset:144
    s_waitcnt lgkmcnt(8)
    v_fmac_f32 v132, v30, v124
    v_fmac_f32 v133, v31, v125
    v_cvt_pk_bf16_f32 v10, v132, v133
    v_fmac_f32 v134, v32, v126
    v_fmac_f32 v135, v33, v127
    v_cvt_pk_bf16_f32 v11, v134, v135
    v_fmac_f32 v136, v34, v128
    v_fmac_f32 v137, v35, v129
    v_cvt_pk_bf16_f32 v12, v136, v137
    v_fmac_f32 v138, v36, v130
    v_fmac_f32 v139, v37, v131
    v_cvt_pk_bf16_f32 v13, v138, v139
    buffer_store_dwordx4 v[10:13], v2, s[4:7], s24 offen offset:0 sc1
    ds_read_b128 v[172:175], v8 offset:512
    ds_read_b128 v[176:179], v8 offset:528
    ds_read_b128 v[180:183], v8 offset:192
    ds_read_b128 v[184:187], v8 offset:208
    s_waitcnt lgkmcnt(8)
    v_fmac_f32 v148, v38, v140
    v_fmac_f32 v149, v39, v141
    v_cvt_pk_bf16_f32 v14, v148, v149
    v_fmac_f32 v150, v40, v142
    v_fmac_f32 v151, v41, v143
    v_cvt_pk_bf16_f32 v15, v150, v151
    v_fmac_f32 v152, v42, v144
    v_fmac_f32 v153, v43, v145
    v_cvt_pk_bf16_f32 v16, v152, v153
    v_fmac_f32 v154, v44, v146
    v_fmac_f32 v155, v45, v147
    v_cvt_pk_bf16_f32 v17, v154, v155
    buffer_store_dwordx4 v[14:17], v2, s[4:7], s24 offen offset:1024 sc1
    ds_read_b128 v[188:191], v8 offset:576
    ds_read_b128 v[192:195], v8 offset:592
    ds_read_b128 v[196:199], v8 offset:256
    ds_read_b128 v[200:203], v8 offset:272
    s_waitcnt lgkmcnt(8)
    v_fmac_f32 v164, v46, v156
    v_fmac_f32 v165, v47, v157
    v_cvt_pk_bf16_f32 v18, v164, v165
    v_fmac_f32 v166, v48, v158
    v_fmac_f32 v167, v49, v159
    v_cvt_pk_bf16_f32 v19, v166, v167
    v_fmac_f32 v168, v50, v160
    v_fmac_f32 v169, v51, v161
    v_cvt_pk_bf16_f32 v20, v168, v169
    v_fmac_f32 v170, v52, v162
    v_fmac_f32 v171, v53, v163
    v_cvt_pk_bf16_f32 v21, v170, v171
    buffer_store_dwordx4 v[18:21], v2, s[4:7], s24 offen offset:2048 sc1
    s_waitcnt lgkmcnt(4)
    v_fmac_f32 v180, v54, v172
    v_fmac_f32 v181, v55, v173
    v_cvt_pk_bf16_f32 v22, v180, v181
    v_fmac_f32 v182, v56, v174
    v_fmac_f32 v183, v57, v175
    v_cvt_pk_bf16_f32 v23, v182, v183
    v_fmac_f32 v184, v58, v176
    v_fmac_f32 v185, v59, v177
    v_cvt_pk_bf16_f32 v24, v184, v185
    v_fmac_f32 v186, v60, v178
    v_fmac_f32 v187, v61, v179
    v_cvt_pk_bf16_f32 v25, v186, v187
    buffer_store_dwordx4 v[22:25], v2, s[4:7], s24 offen offset:3072 sc1
    s_waitcnt lgkmcnt(0)
    v_fmac_f32 v196, v62, v188
    v_fmac_f32 v197, v63, v189
    v_cvt_pk_bf16_f32 v26, v196, v197
    v_fmac_f32 v198, v64, v190
    v_fmac_f32 v199, v65, v191
    v_cvt_pk_bf16_f32 v27, v198, v199
    v_fmac_f32 v200, v66, v192
    v_fmac_f32 v201, v67, v193
    v_cvt_pk_bf16_f32 v28, v200, v201
    v_fmac_f32 v202, v68, v194
    v_fmac_f32 v203, v69, v195
    v_cvt_pk_bf16_f32 v29, v202, v203
    s_add_u32 s24, s24, 4096
    buffer_store_dwordx4 v[26:29], v2, s[4:7], s24 offen offset:0 sc1
    s_add_u32 s68, s68, 64
    v_mov_b32 v70, 163776
    v_mov_b32 v71, 1
    s_mov_b64 exec, 1
    s_waitcnt vmcnt(0)
    ds_add_rtn_u32 v72, v70, v71
    s_waitcnt lgkmcnt(0)
    v_readfirstlane_b32 s74, v72
    s_cmp_lg_u32 s74, 7
    s_cbranch_scc1 L_p0_nosig
    s_mov_b64 exec, 0xff
    s_lshl_b32 s74, s68, 7
    s_add_u32 s74, s74, 262144
    v_mov_b32 v70, s76
    v_mov_b32 v71, s77
    v_mov_b32 v72, 0
    v_mov_b32 v73, 0
    buffer_store_dwordx4 v[70:73], v2, s[4:7], s74 offen sc1
L_p0_nosig:
    s_mov_b64 exec, -1
    s_branch L_p0_done
L_p0_done:
    s_and_b32 s23, s67, 7
    s_lshl_b32 s21, s66, 3
    s_add_u32 s23, s23, s21
    s_lshr_b32 s21, s67, 3
    v_bfe_u32 v10, v1, 2, 2
    v_lshl_add_u32 v10, v4, 3, v10
    v_bfe_u32 v9, v1, 4, 1
    v_lshlrev_b32 v9, 5, v9
    v_and_b32 v11, 1, v1
    v_lshl_add_u32 v9, v11, 4, v9
    v_bfe_u32 v11, v1, 1, 1
    v_lshl_add_u32 v9, v11, 3, v9
    s_sub_u32 s20, s3, 5
    s_cmp_ge_u32 s20, 2
    s_cbranch_scc1 L_p1_coop
    s_cmp_lg_u32 s21, 0
    s_cbranch_scc1 L_p1_coop
    s_cmp_eq_u32 s3, 5
    s_cselect_b32 s12, s40, s42
    s_cselect_b32 s13, s41, s43
    s_mov_b32 s14, 25600
    s_mov_b32 s15, 0x20000
    s_mov_b32 s29, 108544
    s_cselect_b32 s29, 81920, s29
    s_add_u32 m0, s29, 0
    s_mov_b32 s25, 0
    buffer_load_dwordx4 v2, s[12:15], s25 offen lds
    s_add_u32 m0, s29, 1024
    s_mov_b32 s25, 1024
    buffer_load_dwordx4 v2, s[12:15], s25 offen lds
    s_add_u32 m0, s29, 2048
    s_mov_b32 s25, 2048
    buffer_load_dwordx4 v2, s[12:15], s25 offen lds
    s_add_u32 m0, s29, 3072
    s_mov_b32 s25, 3072
    buffer_load_dwordx4 v2, s[12:15], s25 offen lds
    s_add_u32 m0, s29, 4096
    s_mov_b32 s25, 4096
    buffer_load_dwordx4 v2, s[12:15], s25 offen lds
    s_add_u32 m0, s29, 5120
    s_mov_b32 s25, 5120
    buffer_load_dwordx4 v2, s[12:15], s25 offen lds
    s_add_u32 m0, s29, 6144
    s_mov_b32 s25, 6144
    buffer_load_dwordx4 v2, s[12:15], s25 offen lds
    s_add_u32 m0, s29, 7168
    s_mov_b32 s25, 7168
    buffer_load_dwordx4 v2, s[12:15], s25 offen lds
    s_add_u32 m0, s29, 8192
    s_mov_b32 s25, 8192
    buffer_load_dwordx4 v2, s[12:15], s25 offen lds
    s_add_u32 m0, s29, 9216
    s_mov_b32 s25, 9216
    buffer_load_dwordx4 v2, s[12:15], s25 offen lds
    s_add_u32 m0, s29, 10240
    s_mov_b32 s25, 10240
    buffer_load_dwordx4 v2, s[12:15], s25 offen lds
    s_add_u32 m0, s29, 11264
    s_mov_b32 s25, 11264
    buffer_load_dwordx4 v2, s[12:15], s25 offen lds
    s_add_u32 m0, s29, 12288
    s_mov_b32 s25, 12288
    buffer_load_dwordx4 v2, s[12:15], s25 offen lds
    s_add_u32 m0, s29, 13312
    s_mov_b32 s25, 13312
    buffer_load_dwordx4 v2, s[12:15], s25 offen lds
    s_add_u32 m0, s29, 14336
    s_mov_b32 s25, 14336
    buffer_load_dwordx4 v2, s[12:15], s25 offen lds
    s_add_u32 m0, s29, 15360
    s_mov_b32 s25, 15360
    buffer_load_dwordx4 v2, s[12:15], s25 offen lds
    s_add_u32 m0, s29, 16384
    s_mov_b32 s25, 16384
    buffer_load_dwordx4 v2, s[12:15], s25 offen lds
    s_add_u32 m0, s29, 17408
    s_mov_b32 s25, 17408
    buffer_load_dwordx4 v2, s[12:15], s25 offen lds
    s_add_u32 m0, s29, 18432
    s_mov_b32 s25, 18432
    buffer_load_dwordx4 v2, s[12:15], s25 offen lds
    s_add_u32 m0, s29, 19456
    s_mov_b32 s25, 19456
    buffer_load_dwordx4 v2, s[12:15], s25 offen lds
    s_add_u32 m0, s29, 20480
    s_mov_b32 s25, 20480
    buffer_load_dwordx4 v2, s[12:15], s25 offen lds
    s_add_u32 m0, s29, 21504
    s_mov_b32 s25, 21504
    buffer_load_dwordx4 v2, s[12:15], s25 offen lds
    s_add_u32 m0, s29, 22528
    s_mov_b32 s25, 22528
    buffer_load_dwordx4 v2, s[12:15], s25 offen lds
    s_add_u32 m0, s29, 23552
    s_mov_b32 s25, 23552
    buffer_load_dwordx4 v2, s[12:15], s25 offen lds
    s_add_u32 m0, s29, 24576
    s_mov_b32 s25, 24576
    buffer_load_dwordx4 v2, s[12:15], s25 offen lds
L_p1_coop:
    s_mov_b32 s8, s38
    s_mov_b32 s9, s39
    s_mov_b32 s10, 819200
    s_mov_b32 s11, 0x20000
    v_add_u32 v11, 0, v1
    v_mul_u32_u24 v12, 3277, v11
    v_lshrrev_b32 v12, 16, v12
    v_mul_u32_u24 v13, 20, v12
    v_sub_u32 v13, v11, v13
    v_mul_u32_u24 v12, 1280, v12
    v_lshl_add_u32 v16, v13, 4, v12
    v_add_u32 v11, 64, v1
    v_mul_u32_u24 v12, 3277, v11
    v_lshrrev_b32 v12, 16, v12
    v_mul_u32_u24 v13, 20, v12
    v_sub_u32 v13, v11, v13
    v_mul_u32_u24 v12, 1280, v12
    v_lshl_add_u32 v17, v13, 4, v12
    v_add_u32 v11, 128, v1
    v_mul_u32_u24 v12, 3277, v11
    v_lshrrev_b32 v12, 16, v12
    v_mul_u32_u24 v13, 20, v12
    v_sub_u32 v13, v11, v13
    v_mul_u32_u24 v12, 1280, v12
    v_lshl_add_u32 v18, v13, 4, v12
    v_add_u32 v11, 192, v1
    v_mul_u32_u24 v12, 3277, v11
    v_lshrrev_b32 v12, 16, v12
    v_mul_u32_u24 v13, 20, v12
    v_sub_u32 v13, v11, v13
    v_mul_u32_u24 v12, 1280, v12
    v_lshl_add_u32 v19, v13, 4, v12
    v_add_u32 v11, 256, v1
    v_mul_u32_u24 v12, 3277, v11
    v_lshrrev_b32 v12, 16, v12
    v_mul_u32_u24 v13, 20, v12
    v_sub_u32 v13, v11, v13
    v_mul_u32_u24 v12, 1280, v12
    v_lshl_add_u32 v20, v13, 4, v12
    s_lshr_b32 s24, s67, 3
    s_mul_i32 s24, s24, 320
    s_mul_i32 s25, s3, 20480
    s_add_u32 s24, s24, s25
    s_mul_i32 s28, s3, 5120
    v_mul_u32_u24 v8, 320, v10
    v_add_u32 v8, v8, v9
    s_lshl_b32 s25, s3, 6
    v_add_u32 v8, s25, v8
    v_add_u32 v14, 40960, v8
    s_cmp_eq_u32 s69, 1
    s_cbranch_scc1 L_p1_s2
    s_add_u32 m0, s28, 0
    s_add_u32 s25, s24, 0
    buffer_load_dwordx4 v16, s[8:11], s25 offen lds
    s_add_u32 m0, s28, 1024
    s_nop 0
    buffer_load_dwordx4 v17, s[8:11], s25 offen lds
    s_add_u32 m0, s28, 2048
    s_nop 0
    buffer_load_dwordx4 v18, s[8:11], s25 offen lds
    s_add_u32 m0, s28, 3072
    s_nop 0
    buffer_load_dwordx4 v19, s[8:11], s25 offen lds
    s_add_u32 m0, s28, 4096
    s_nop 0
    buffer_load_dwordx4 v20, s[8:11], s25 offen lds
    s_add_u32 m0, s28, 40960
    s_add_u32 s25, s24, 163840
    buffer_load_dwordx4 v16, s[8:11], s25 offen lds
    s_add_u32 m0, s28, 41984
    s_nop 0
    buffer_load_dwordx4 v17, s[8:11], s25 offen lds
    s_add_u32 m0, s28, 43008
    s_nop 0
    buffer_load_dwordx4 v18, s[8:11], s25 offen lds
    s_add_u32 m0, s28, 44032
    s_nop 0
    buffer_load_dwordx4 v19, s[8:11], s25 offen lds
    s_add_u32 m0, s28, 45056
    s_nop 0
    buffer_load_dwordx4 v20, s[8:11], s25 offen lds
L_p1_s2:
    s_waitcnt vmcnt(5)
    s_barrier
    s_cmp_ge_u32 s3, 5
    s_cbranch_scc1 L_p1_nr0
    ds_read_b64_tr_b16 v[96:97], v8 offset:0
    ds_read_b64_tr_b16 v[98:99], v8 offset:1280
    ds_read_b64_tr_b16 v[100:101], v8 offset:5120
    ds_read_b64_tr_b16 v[102:103], v8 offset:6400
    ds_read_b64_tr_b16 v[104:105], v8 offset:10240
    ds_read_b64_tr_b16 v[106:107], v8 offset:11520
    ds_read_b64_tr_b16 v[108:109], v8 offset:15360
    ds_read_b64_tr_b16 v[110:111], v8 offset:16640
    ds_read_b64_tr_b16 v[112:113], v8 offset:20480
    ds_read_b64_tr_b16 v[114:115], v8 offset:21760
    ds_read_b64_tr_b16 v[116:117], v8 offset:25600
    ds_read_b64_tr_b16 v[118:119], v8 offset:26880
    ds_read_b64_tr_b16 v[120:121], v8 offset:30720
    ds_read_b64_tr_b16 v[122:123], v8 offset:32000
    ds_read_b64_tr_b16 v[124:125], v8 offset:35840
    ds_read_b64_tr_b16 v[126:127], v8 offset:37120
    s_waitcnt lgkmcnt(0)
L_p1_nr0:
    s_barrier
    s_add_u32 m0, s28, 0
    s_add_u32 s25, s24, 327680
    buffer_load_dwordx4 v16, s[8:11], s25 offen lds
    s_add_u32 m0, s28, 1024
    s_nop 0
    buffer_load_dwordx4 v17, s[8:11], s25 offen lds
    s_add_u32 m0, s28, 2048
    s_nop 0
    buffer_load_dwordx4 v18, s[8:11], s25 offen lds
    s_add_u32 m0, s28, 3072
    s_nop 0
    buffer_load_dwordx4 v19, s[8:11], s25 offen lds
    s_add_u32 m0, s28, 4096
    s_nop 0
    buffer_load_dwordx4 v20, s[8:11], s25 offen lds
    s_waitcnt vmcnt(5)
    s_barrier
    s_cmp_ge_u32 s3, 5
    s_cbranch_scc1 L_p1_nr1
    ds_read_b64_tr_b16 v[128:129], v8 offset:40960
    ds_read_b64_tr_b16 v[130:131], v8 offset:42240
    ds_read_b64_tr_b16 v[132:133], v8 offset:46080
    ds_read_b64_tr_b16 v[134:135], v8 offset:47360
    ds_read_b64_tr_b16 v[136:137], v8 offset:51200
    ds_read_b64_tr_b16 v[138:139], v8 offset:52480
    ds_read_b64_tr_b16 v[140:141], v8 offset:56320
    ds_read_b64_tr_b16 v[142:143], v8 offset:57600
    ds_read_b64_tr_b16 v[144:145], v8 offset:61440
    ds_read_b64_tr_b16 v[146:147], v8 offset:62720
    ds_read_b64_tr_b16 v[148:149], v14 offset:25600
    ds_read_b64_tr_b16 v[150:151], v14 offset:26880
    ds_read_b64_tr_b16 v[152:153], v14 offset:30720
    ds_read_b64_tr_b16 v[154:155], v14 offset:32000
    ds_read_b64_tr_b16 v[156:157], v14 offset:35840
    ds_read_b64_tr_b16 v[158:159], v14 offset:37120
    s_waitcnt lgkmcnt(0)
L_p1_nr1:
    s_barrier
    s_add_u32 m0, s28, 40960
    s_add_u32 s25, s24, 491520
    buffer_load_dwordx4 v16, s[8:11], s25 offen lds
    s_add_u32 m0, s28, 41984
    s_nop 0
    buffer_load_dwordx4 v17, s[8:11], s25 offen lds
    s_add_u32 m0, s28, 43008
    s_nop 0
    buffer_load_dwordx4 v18, s[8:11], s25 offen lds
    s_add_u32 m0, s28, 44032
    s_nop 0
    buffer_load_dwordx4 v19, s[8:11], s25 offen lds
    s_add_u32 m0, s28, 45056
    s_nop 0
    buffer_load_dwordx4 v20, s[8:11], s25 offen lds
    s_waitcnt vmcnt(5)
    s_barrier
    s_cmp_ge_u32 s3, 5
    s_cbranch_scc1 L_p1_nr2
    ds_read_b64_tr_b16 v[160:161], v8 offset:0
    ds_read_b64_tr_b16 v[162:163], v8 offset:1280
    ds_read_b64_tr_b16 v[164:165], v8 offset:5120
    ds_read_b64_tr_b16 v[166:167], v8 offset:6400
    ds_read_b64_tr_b16 v[168:169], v8 offset:10240
    ds_read_b64_tr_b16 v[170:171], v8 offset:11520
    ds_read_b64_tr_b16 v[172:173], v8 offset:15360
    ds_read_b64_tr_b16 v[174:175], v8 offset:16640
    ds_read_b64_tr_b16 v[176:177], v8 offset:20480
    ds_read_b64_tr_b16 v[178:179], v8 offset:21760
    ds_read_b64_tr_b16 v[180:181], v8 offset:25600
    ds_read_b64_tr_b16 v[182:183], v8 offset:26880
    ds_read_b64_tr_b16 v[184:185], v8 offset:30720
    ds_read_b64_tr_b16 v[186:187], v8 offset:32000
    ds_read_b64_tr_b16 v[188:189], v8 offset:35840
    ds_read_b64_tr_b16 v[190:191], v8 offset:37120
    s_waitcnt lgkmcnt(0)
L_p1_nr2:
    s_barrier
    s_add_u32 m0, s28, 0
    s_add_u32 s25, s24, 655360
    buffer_load_dwordx4 v16, s[8:11], s25 offen lds
    s_add_u32 m0, s28, 1024
    s_nop 0
    buffer_load_dwordx4 v17, s[8:11], s25 offen lds
    s_add_u32 m0, s28, 2048
    s_nop 0
    buffer_load_dwordx4 v18, s[8:11], s25 offen lds
    s_add_u32 m0, s28, 3072
    s_nop 0
    buffer_load_dwordx4 v19, s[8:11], s25 offen lds
    s_add_u32 m0, s28, 4096
    s_nop 0
    buffer_load_dwordx4 v20, s[8:11], s25 offen lds
    s_waitcnt vmcnt(5)
    s_barrier
    s_cmp_ge_u32 s3, 5
    s_cbranch_scc1 L_p1_nr3
    ds_read_b64_tr_b16 v[192:193], v8 offset:40960
    ds_read_b64_tr_b16 v[194:195], v8 offset:42240
    ds_read_b64_tr_b16 v[196:197], v8 offset:46080
    ds_read_b64_tr_b16 v[198:199], v8 offset:47360
    ds_read_b64_tr_b16 v[200:201], v8 offset:51200
    ds_read_b64_tr_b16 v[202:203], v8 offset:52480
    ds_read_b64_tr_b16 v[204:205], v8 offset:56320
    ds_read_b64_tr_b16 v[206:207], v8 offset:57600
    ds_read_b64_tr_b16 v[208:209], v8 offset:61440
    ds_read_b64_tr_b16 v[210:211], v8 offset:62720
    ds_read_b64_tr_b16 v[212:213], v14 offset:25600
    ds_read_b64_tr_b16 v[214:215], v14 offset:26880
    ds_read_b64_tr_b16 v[216:217], v14 offset:30720
    ds_read_b64_tr_b16 v[218:219], v14 offset:32000
    ds_read_b64_tr_b16 v[220:221], v14 offset:35840
    ds_read_b64_tr_b16 v[222:223], v14 offset:37120
    s_waitcnt lgkmcnt(0)
L_p1_nr3:
    s_waitcnt vmcnt(0)
    s_barrier
    s_cmp_ge_u32 s3, 5
    s_cbranch_scc1 L_p1_nr4
    ds_read_b64_tr_b16 v[224:225], v8 offset:0
    ds_read_b64_tr_b16 v[226:227], v8 offset:1280
    ds_read_b64_tr_b16 v[228:229], v8 offset:5120
    ds_read_b64_tr_b16 v[230:231], v8 offset:6400
    ds_read_b64_tr_b16 v[232:233], v8 offset:10240
    ds_read_b64_tr_b16 v[234:235], v8 offset:11520
    ds_read_b64_tr_b16 v[236:237], v8 offset:15360
    ds_read_b64_tr_b16 v[238:239], v8 offset:16640
    ds_read_b64_tr_b16 v[240:241], v8 offset:20480
    ds_read_b64_tr_b16 v[242:243], v8 offset:21760
    ds_read_b64_tr_b16 v[244:245], v8 offset:25600
    ds_read_b64_tr_b16 v[246:247], v8 offset:26880
    ds_read_b64_tr_b16 v[248:249], v8 offset:30720
    ds_read_b64_tr_b16 v[250:251], v8 offset:32000
    ds_read_b64_tr_b16 v[252:253], v8 offset:35840
    ds_read_b64_tr_b16 v[254:255], v8 offset:37120
    s_waitcnt lgkmcnt(0)
L_p1_nr4:
    s_cmp_lt_u32 s3, 5
    s_cbranch_scc1 L_p1_h
    s_cmp_eq_u32 s3, 7
    s_cbranch_scc1 L_p1_w7
    s_cmp_lg_u32 s21, 0
    s_cbranch_scc1 L_p1_fin
    s_setprio 3
    v_mul_u32_u24 v8, 40, v10
    v_add3_u32 v8, v8, v9, s29
    ds_read_b64_tr_b16 v[96:97], v8 offset:0
    ds_read_b64_tr_b16 v[98:99], v8 offset:160
    ds_read_b64_tr_b16 v[100:101], v8 offset:640
    ds_read_b64_tr_b16 v[102:103], v8 offset:800
    ds_read_b64_tr_b16 v[104:105], v8 offset:1280
    ds_read_b64_tr_b16 v[106:107], v8 offset:1440
    ds_read_b64_tr_b16 v[108:109], v8 offset:1920
    ds_read_b64_tr_b16 v[110:111], v8 offset:2080
    ds_read_b64_tr_b16 v[112:113], v8 offset:2560
    ds_read_b64_tr_b16 v[114:115], v8 offset:2720
    ds_read_b64_tr_b16 v[116:117], v8 offset:3200
    ds_read_b64_tr_b16 v[118:119], v8 offset:3360
    ds_read_b64_tr_b16 v[120:121], v8 offset:3840
    ds_read_b64_tr_b16 v[122:123], v8 offset:4000
    ds_read_b64_tr_b16 v[124:125], v8 offset:4480
    ds_read_b64_tr_b16 v[126:127], v8 offset:4640
    ds_read_b64_tr_b16 v[128:129], v8 offset:5120
    ds_read_b64_tr_b16 v[130:131], v8 offset:5280
    ds_read_b64_tr_b16 v[132:133], v8 offset:5760
    ds_read_b64_tr_b16 v[134:135], v8 offset:5920
    ds_read_b64_tr_b16 v[136:137], v8 offset:6400
    ds_read_b64_tr_b16 v[138:139], v8 offset:6560
    ds_read_b64_tr_b16 v[140:141], v8 offset:7040
    ds_read_b64_tr_b16 v[142:143], v8 offset:7200
    ds_read_b64_tr_b16 v[144:145], v8 offset:7680
    ds_read_b64_tr_b16 v[146:147], v8 offset:7840
    ds_read_b64_tr_b16 v[148:149], v8 offset:8320
    ds_read_b64_tr_b16 v[150:151], v8 offset:8480
    ds_read_b64_tr_b16 v[152:153], v8 offset:8960
    ds_read_b64_tr_b16 v[154:155], v8 offset:9120
    ds_read_b64_tr_b16 v[156:157], v8 offset:9600
    ds_read_b64_tr_b16 v[158:159], v8 offset:9760
    ds_read_b64_tr_b16 v[160:161], v8 offset:10240
    ds_read_b64_tr_b16 v[162:163], v8 offset:10400
    ds_read_b64_tr_b16 v[164:165], v8 offset:10880
    ds_read_b64_tr_b16 v[166:167], v8 offset:11040
    ds_read_b64_tr_b16 v[168:169], v8 offset:11520
    ds_read_b64_tr_b16 v[170:171], v8 offset:11680
    ds_read_b64_tr_b16 v[172:173], v8 offset:12160
    ds_read_b64_tr_b16 v[174:175], v8 offset:12320
    ds_read_b64_tr_b16 v[176:177], v8 offset:12800
    ds_read_b64_tr_b16 v[178:179], v8 offset:12960
    ds_read_b64_tr_b16 v[180:181], v8 offset:13440
    ds_read_b64_tr_b16 v[182:183], v8 offset:13600
    ds_read_b64_tr_b16 v[184:185], v8 offset:14080
    ds_read_b64_tr_b16 v[186:187], v8 offset:14240
    ds_read_b64_tr_b16 v[188:189], v8 offset:14720
    ds_read_b64_tr_b16 v[190:191], v8 offset:14880
    ds_read_b64_tr_b16 v[192:193], v8 offset:15360
    ds_read_b64_tr_b16 v[194:195], v8 offset:15520
    ds_read_b64_tr_b16 v[196:197], v8 offset:16000
    ds_read_b64_tr_b16 v[198:199], v8 offset:16160
    ds_read_b64_tr_b16 v[200:201], v8 offset:16640
    ds_read_b64_tr_b16 v[202:203], v8 offset:16800
    ds_read_b64_tr_b16 v[204:205], v8 offset:17280
    ds_read_b64_tr_b16 v[206:207], v8 offset:17440
    ds_read_b64_tr_b16 v[208:209], v8 offset:17920
    ds_read_b64_tr_b16 v[210:211], v8 offset:18080
    ds_read_b64_tr_b16 v[212:213], v8 offset:18560
    ds_read_b64_tr_b16 v[214:215], v8 offset:18720
    ds_read_b64_tr_b16 v[216:217], v8 offset:19200
    ds_read_b64_tr_b16 v[218:219], v8 offset:19360
    ds_read_b64_tr_b16 v[220:221], v8 offset:19840
    ds_read_b64_tr_b16 v[222:223], v8 offset:20000
    ds_read_b64_tr_b16 v[224:225], v8 offset:20480
    ds_read_b64_tr_b16 v[226:227], v8 offset:20640
    ds_read_b64_tr_b16 v[228:229], v8 offset:21120
    ds_read_b64_tr_b16 v[230:231], v8 offset:21280
    ds_read_b64_tr_b16 v[232:233], v8 offset:21760
    ds_read_b64_tr_b16 v[234:235], v8 offset:21920
    ds_read_b64_tr_b16 v[236:237], v8 offset:22400
    ds_read_b64_tr_b16 v[238:239], v8 offset:22560
    ds_read_b64_tr_b16 v[240:241], v8 offset:23040
    ds_read_b64_tr_b16 v[242:243], v8 offset:23200
    ds_read_b64_tr_b16 v[244:245], v8 offset:23680
    ds_read_b64_tr_b16 v[246:247], v8 offset:23840
    ds_read_b64_tr_b16 v[248:249], v8 offset:24320
    ds_read_b64_tr_b16 v[250:251], v8 offset:24480
    ds_read_b64_tr_b16 v[252:253], v8 offset:24960
    ds_read_b64_tr_b16 v[254:255], v8 offset:25120
    s_waitcnt lgkmcnt(0)
    s_branch L_p1_h
L_p1_fin:
    s_sub_u32 s20, s2, 246
    s_cmp_ge_u32 s20, 4
    s_cbranch_scc1 L_p1_h
    s_cmp_lg_u32 s3, 5
    s_cbranch_scc1 L_p1_h
    s_add_u32 s22, s20, 2
    s_mul_i32 s24, s22, 80
    s_add_u32 s24, s24, 1536
    v_add_u32 v8, s24, v1
    v_min_u32 v9, 15, v1
    v_add3_u32 v9, v9, s24, 64
    v_lshlrev_b32 v8, 7, v8
    s_mov_b32 s74, 0
    s_mov_b32 s75, 262144
L_p1f_poll:
    buffer_load_dwordx2 v[10:11], v8, s[4:7], s75 offen sc1
    s_add_u32 s74, s74, 1
    s_waitcnt vmcnt(0)
    v_cmp_ne_u64 vcc, s[76:77], v[10:11]
    s_cmp_gt_u32 s74, 400000
    s_cbranch_scc1 L_p1f_go
    s_nop 2
    s_cbranch_vccz L_p1f_go
    s_sleep 1
    s_branch L_p1f_poll
L_p1f_go:
    v_lshlrev_b32 v9, 7, v9
    s_mov_b32 s74, 0
    s_mov_b32 s75, 262144
L_p1g_poll:
    buffer_load_dwordx2 v[10:11], v9, s[4:7], s75 offen sc1
    s_add_u32 s74, s74, 1
    s_waitcnt vmcnt(0)
    v_cmp_ne_u64 vcc, s[76:77], v[10:11]
    s_cmp_gt_u32 s74, 400000
    s_cbranch_scc1 L_p1g_go
    s_nop 2
    s_cbranch_vccz L_p1g_go
    s_sleep 1
    s_branch L_p1g_poll
L_p1g_go:
    s_mul_i32 s24, s22, 2560
    s_cmp_eq_u32 s22, 4
    s_cselect_b32 s26, 1.0, 0
    s_cmp_eq_u32 s22, 3
    s_cselect_b32 s27, 1280, 0
    s_add_u32 s27, s27, 24576
    v_lshlrev_b32 v8, 3, v1
    v_lshlrev_b32 v9, 2, v1
    s_mov_b32 s29, 0
    s_add_u32 s25, s24, 524288
    buffer_load_dwordx2 v[20:21], v8, s[4:7], s25 offen offset:0 sc1
    buffer_load_dwordx2 v[28:29], v8, s[4:7], s25 offen offset:512 sc1
    buffer_load_dwordx2 v[36:37], v8, s[4:7], s25 offen offset:1024 sc1
    buffer_load_dwordx2 v[44:45], v8, s[4:7], s25 offen offset:1536 sc1
    buffer_load_dwordx2 v[52:53], v8, s[4:7], s25 offen offset:2048 sc1
    s_add_u32 s25, s25, 15360
    buffer_load_dwordx2 v[22:23], v8, s[4:7], s25 offen offset:0 sc1
    buffer_load_dwordx2 v[30:31], v8, s[4:7], s25 offen offset:512 sc1
    buffer_load_dwordx2 v[38:39], v8, s[4:7], s25 offen offset:1024 sc1
    buffer_load_dwordx2 v[46:47], v8, s[4:7], s25 offen offset:1536 sc1
    buffer_load_dwordx2 v[54:55], v8, s[4:7], s25 offen offset:2048 sc1
    s_add_u32 s25, s25, 15360
    buffer_load_dwordx2 v[24:25], v8, s[4:7], s25 offen offset:0 sc1
    buffer_load_dwordx2 v[32:33], v8, s[4:7], s25 offen offset:512 sc1
    buffer_load_dwordx2 v[40:41], v8, s[4:7], s25 offen offset:1024 sc1
    buffer_load_dwordx2 v[48:49], v8, s[4:7], s25 offen offset:1536 sc1
    buffer_load_dwordx2 v[56:57], v8, s[4:7], s25 offen offset:2048 sc1
    s_add_u32 s25, s25, 15360
    buffer_load_dwordx2 v[26:27], v8, s[4:7], s25 offen offset:0 sc1
    buffer_load_dwordx2 v[34:35], v8, s[4:7], s25 offen offset:512 sc1
    buffer_load_dwordx2 v[42:43], v8, s[4:7], s25 offen offset:1024 sc1
    buffer_load_dwordx2 v[50:51], v8, s[4:7], s25 offen offset:1536 sc1
    buffer_load_dwordx2 v[58:59], v8, s[4:7], s25 offen offset:2048 sc1
    s_add_u32 s25, s25, 15360
    s_sub_u32 s25, s22, 3
    s_cmp_ge_u32 s25, 2
    s_cselect_b32 s27, 0x7fffff00, s27
    s_waitcnt vmcnt(0)
    v_pk_add_f32 v[20:21], v[20:21], v[22:23]
    v_pk_add_f32 v[24:25], v[24:25], v[26:27]
    v_pk_add_f32 v[20:21], v[20:21], v[24:25]
    v_cvt_pk_bf16_f32 v22, v20, v21
    v_lshlrev_b32 v20, 16, v22
    v_and_b32 v21, 0xffff0000, v22
    v_add_f32 v20, s26, v20
    v_add_f32 v21, s26, v21
    v_cvt_pk_bf16_f32 v22, v20, v21
    v_lshlrev_b32 v20, 16, v22
    v_and_b32 v21, 0xffff0000, v22
    buffer_store_dwordx2 v[20:21], v8, s[4:7], s24 offen offset:0 sc1
    buffer_store_dword v22, v9, s[4:7], s27 offen offset:0 sc1
    v_pk_add_f32 v[28:29], v[28:29], v[30:31]
    v_pk_add_f32 v[32:33], v[32:33], v[34:35]
    v_pk_add_f32 v[28:29], v[28:29], v[32:33]
    v_cvt_pk_bf16_f32 v30, v28, v29
    v_lshlrev_b32 v28, 16, v30
    v_and_b32 v29, 0xffff0000, v30
    v_add_f32 v28, s26, v28
    v_add_f32 v29, s26, v29
    v_cvt_pk_bf16_f32 v30, v28, v29
    v_lshlrev_b32 v28, 16, v30
    v_and_b32 v29, 0xffff0000, v30
    buffer_store_dwordx2 v[28:29], v8, s[4:7], s24 offen offset:512 sc1
    buffer_store_dword v30, v9, s[4:7], s27 offen offset:256 sc1
    v_pk_add_f32 v[36:37], v[36:37], v[38:39]
    v_pk_add_f32 v[40:41], v[40:41], v[42:43]
    v_pk_add_f32 v[36:37], v[36:37], v[40:41]
    v_cvt_pk_bf16_f32 v38, v36, v37
    v_lshlrev_b32 v36, 16, v38
    v_and_b32 v37, 0xffff0000, v38
    v_add_f32 v36, s26, v36
    v_add_f32 v37, s26, v37
    v_cvt_pk_bf16_f32 v38, v36, v37
    v_lshlrev_b32 v36, 16, v38
    v_and_b32 v37, 0xffff0000, v38
    buffer_store_dwordx2 v[36:37], v8, s[4:7], s24 offen offset:1024 sc1
    buffer_store_dword v38, v9, s[4:7], s27 offen offset:512 sc1
    v_pk_add_f32 v[44:45], v[44:45], v[46:47]
    v_pk_add_f32 v[48:49], v[48:49], v[50:51]
    v_pk_add_f32 v[44:45], v[44:45], v[48:49]
    v_cvt_pk_bf16_f32 v46, v44, v45
    v_lshlrev_b32 v44, 16, v46
    v_and_b32 v45, 0xffff0000, v46
    v_add_f32 v44, s26, v44
    v_add_f32 v45, s26, v45
    v_cvt_pk_bf16_f32 v46, v44, v45
    v_lshlrev_b32 v44, 16, v46
    v_and_b32 v45, 0xffff0000, v46
    buffer_store_dwordx2 v[44:45], v8, s[4:7], s24 offen offset:1536 sc1
    buffer_store_dword v46, v9, s[4:7], s27 offen offset:768 sc1
    v_pk_add_f32 v[52:53], v[52:53], v[54:55]
    v_pk_add_f32 v[56:57], v[56:57], v[58:59]
    v_pk_add_f32 v[52:53], v[52:53], v[56:57]
    v_cvt_pk_bf16_f32 v54, v52, v53
    v_lshlrev_b32 v52, 16, v54
    v_and_b32 v53, 0xffff0000, v54
    v_add_f32 v52, s26, v52
    v_add_f32 v53, s26, v53
    v_cvt_pk_bf16_f32 v54, v52, v53
    v_lshlrev_b32 v52, 16, v54
    v_and_b32 v53, 0xffff0000, v54
    buffer_store_dwordx2 v[52:53], v8, s[4:7], s24 offen offset:2048 sc1
    buffer_store_dword v54, v9, s[4:7], s27 offen offset:1024 sc1
    s_waitcnt vmcnt(0)
    s_mov_b64 exec, 0xff
    s_lshl_b32 s74, s22, 7
    s_add_u32 s74, s74, 262144
    v_mov_b32 v14, s76
    v_mov_b32 v15, s77
    v_mov_b32 v16, 0
    v_mov_b32 v17, 0
    buffer_store_dwordx4 v[14:17], v2, s[4:7], s74 offen sc1
    s_mov_b64 exec, -1
    s_branch L_p1_h
L_p1_w7:
    v_mov_b32 v8, 163780
    v_mov_b32 v9, 0
    ds_write_b32 v8, v9
    s_waitcnt lgkmcnt(0)
    v_mov_b32 v8, 163812
    v_mov_b32 v9, 0
    ds_write_b32 v8, v9
    s_waitcnt lgkmcnt(0)
    s_add_u32 s24, s23, 64
    v_mov_b32 v8, s24
    v_lshlrev_b32 v8, 7, v8
    s_mov_b32 s74, 0
    s_mov_b32 s75, 262144
L_p1_poll:
    buffer_load_dwordx2 v[10:11], v8, s[4:7], s75 offen sc1
    s_add_u32 s74, s74, 1
    s_waitcnt vmcnt(0)
    v_cmp_ne_u64 vcc, s[76:77], v[10:11]
    s_cmp_gt_u32 s74, 400000
    s_cbranch_scc1 L_p1_go
    s_nop 2
    s_cbranch_vccz L_p1_go
    s_sleep 1
    s_branch L_p1_poll
L_p1_go:
L_p1_h:
    s_mul_i32 s24, s23, 40960
    s_add_u32 s24, s24, 2097152
    s_lshl_b32 s25, s3, 10
    s_add_u32 s24, s24, s25
    s_add_u32 s68, s23, 128
    s_barrier
    s_add_u32 m0, s25, 0
    s_add_u32 s26, s24, 0
    buffer_load_dwordx4 v2, s[4:7], s26 offen sc1 lds
    s_add_u32 m0, s25, 8192
    s_add_u32 s26, s24, 8192
    buffer_load_dwordx4 v2, s[4:7], s26 offen sc1 lds
    s_add_u32 m0, s25, 16384
    s_add_u32 s26, s24, 16384
    buffer_load_dwordx4 v2, s[4:7], s26 offen sc1 lds
    s_add_u32 m0, s25, 24576
    s_add_u32 s26, s24, 24576
    buffer_load_dwordx4 v2, s[4:7], s26 offen sc1 lds
    s_add_u32 m0, s25, 32768
    s_add_u32 s26, s24, 32768
    buffer_load_dwordx4 v2, s[4:7], s26 offen sc1 lds
    s_waitcnt vmcnt(0)
    s_barrier
    s_cmp_eq_u32 s3, 7
    s_cbranch_scc1 L_p1_done
    s_cmp_lt_u32 s3, 5
    s_cbranch_scc1 L_p1_mm
    s_cmp_lg_u32 s21, 0
    s_cbranch_scc1 L_p1_done
    s_cmp_eq_u32 s3, 6
    s_cbranch_scc1 L_p1_vpath
L_p1_mm:
    ds_read_b128 v[32:35], v2 offset:0
    ds_read_b128 v[36:39], v2 offset:1024
    ds_read_b128 v[40:43], v2 offset:2048
    ds_read_b128 v[44:47], v2 offset:3072
    ds_read_b128 v[48:51], v2 offset:4096
    ds_read_b128 v[52:55], v2 offset:5120
    ds_read_b128 v[56:59], v2 offset:6144
    ds_read_b128 v[60:63], v2 offset:7168
    s_waitcnt lgkmcnt(7)
    v_mfma_f32_32x32x16_bf16 v[16:31], v[96:99], v[32:35], 0
    s_waitcnt lgkmcnt(6)
    v_mfma_f32_32x32x16_bf16 v[16:31], v[100:103], v[36:39], v[16:31]
    s_waitcnt lgkmcnt(5)
    v_mfma_f32_32x32x16_bf16 v[16:31], v[104:107], v[40:43], v[16:31]
    s_waitcnt lgkmcnt(4)
    v_mfma_f32_32x32x16_bf16 v[16:31], v[108:111], v[44:47], v[16:31]
    s_waitcnt lgkmcnt(3)
    v_mfma_f32_32x32x16_bf16 v[16:31], v[112:115], v[48:51], v[16:31]
    s_waitcnt lgkmcnt(2)
    v_mfma_f32_32x32x16_bf16 v[16:31], v[116:119], v[52:55], v[16:31]
    s_waitcnt lgkmcnt(1)
    v_mfma_f32_32x32x16_bf16 v[16:31], v[120:123], v[56:59], v[16:31]
    s_waitcnt lgkmcnt(0)
    v_mfma_f32_32x32x16_bf16 v[16:31], v[124:127], v[60:63], v[16:31]
    ds_read_b128 v[64:67], v2 offset:8192
    ds_read_b128 v[68:71], v2 offset:9216
    ds_read_b128 v[72:75], v2 offset:10240
    ds_read_b128 v[76:79], v2 offset:11264
    ds_read_b128 v[80:83], v2 offset:12288
    ds_read_b128 v[84:87], v2 offset:13312
    ds_read_b128 v[88:91], v2 offset:14336
    ds_read_b128 v[92:95], v2 offset:15360
    s_waitcnt lgkmcnt(7)
    v_mfma_f32_32x32x16_bf16 v[16:31], v[128:131], v[64:67], v[16:31]
    s_waitcnt lgkmcnt(6)
    v_mfma_f32_32x32x16_bf16 v[16:31], v[132:135], v[68:71], v[16:31]
    s_waitcnt lgkmcnt(5)
    v_mfma_f32_32x32x16_bf16 v[16:31], v[136:139], v[72:75], v[16:31]
    s_waitcnt lgkmcnt(4)
    v_mfma_f32_32x32x16_bf16 v[16:31], v[140:143], v[76:79], v[16:31]
    s_waitcnt lgkmcnt(3)
    v_mfma_f32_32x32x16_bf16 v[16:31], v[144:147], v[80:83], v[16:31]
    s_waitcnt lgkmcnt(2)
    v_mfma_f32_32x32x16_bf16 v[16:31], v[148:151], v[84:87], v[16:31]
    s_waitcnt lgkmcnt(1)
    v_mfma_f32_32x32x16_bf16 v[16:31], v[152:155], v[88:91], v[16:31]
    s_waitcnt lgkmcnt(0)
    v_mfma_f32_32x32x16_bf16 v[16:31], v[156:159], v[92:95], v[16:31]
    ds_read_b128 v[32:35], v2 offset:16384
    ds_read_b128 v[36:39], v2 offset:17408
    ds_read_b128 v[40:43], v2 offset:18432
    ds_read_b128 v[44:47], v2 offset:19456
    ds_read_b128 v[48:51], v2 offset:20480
    ds_read_b128 v[52:55], v2 offset:21504
    ds_read_b128 v[56:59], v2 offset:22528
    ds_read_b128 v[60:63], v2 offset:23552
    s_waitcnt lgkmcnt(7)
    v_mfma_f32_32x32x16_bf16 v[16:31], v[160:163], v[32:35], v[16:31]
    s_waitcnt lgkmcnt(6)
    v_mfma_f32_32x32x16_bf16 v[16:31], v[164:167], v[36:39], v[16:31]
    s_waitcnt lgkmcnt(5)
    v_mfma_f32_32x32x16_bf16 v[16:31], v[168:171], v[40:43], v[16:31]
    s_waitcnt lgkmcnt(4)
    v_mfma_f32_32x32x16_bf16 v[16:31], v[172:175], v[44:47], v[16:31]
    s_waitcnt lgkmcnt(3)
    v_mfma_f32_32x32x16_bf16 v[16:31], v[176:179], v[48:51], v[16:31]
    s_waitcnt lgkmcnt(2)
    v_mfma_f32_32x32x16_bf16 v[16:31], v[180:183], v[52:55], v[16:31]
    s_waitcnt lgkmcnt(1)
    v_mfma_f32_32x32x16_bf16 v[16:31], v[184:187], v[56:59], v[16:31]
    s_waitcnt lgkmcnt(0)
    v_mfma_f32_32x32x16_bf16 v[16:31], v[188:191], v[60:63], v[16:31]
    ds_read_b128 v[64:67], v2 offset:24576
    ds_read_b128 v[68:71], v2 offset:25600
    ds_read_b128 v[72:75], v2 offset:26624
    ds_read_b128 v[76:79], v2 offset:27648
    ds_read_b128 v[80:83], v2 offset:28672
    ds_read_b128 v[84:87], v2 offset:29696
    ds_read_b128 v[88:91], v2 offset:30720
    ds_read_b128 v[92:95], v2 offset:31744
    s_waitcnt lgkmcnt(7)
    v_mfma_f32_32x32x16_bf16 v[16:31], v[192:195], v[64:67], v[16:31]
    s_waitcnt lgkmcnt(6)
    v_mfma_f32_32x32x16_bf16 v[16:31], v[196:199], v[68:71], v[16:31]
    s_waitcnt lgkmcnt(5)
    v_mfma_f32_32x32x16_bf16 v[16:31], v[200:203], v[72:75], v[16:31]
    s_waitcnt lgkmcnt(4)
    v_mfma_f32_32x32x16_bf16 v[16:31], v[204:207], v[76:79], v[16:31]
    s_waitcnt lgkmcnt(3)
    v_mfma_f32_32x32x16_bf16 v[16:31], v[208:211], v[80:83], v[16:31]
    s_waitcnt lgkmcnt(2)
    v_mfma_f32_32x32x16_bf16 v[16:31], v[212:215], v[84:87], v[16:31]
    s_waitcnt lgkmcnt(1)
    v_mfma_f32_32x32x16_bf16 v[16:31], v[216:219], v[88:91], v[16:31]
    s_waitcnt lgkmcnt(0)
    v_mfma_f32_32x32x16_bf16 v[16:31], v[220:223], v[92:95], v[16:31]
    ds_read_b128 v[32:35], v2 offset:32768
    ds_read_b128 v[36:39], v2 offset:33792
    ds_read_b128 v[40:43], v2 offset:34816
    ds_read_b128 v[44:47], v2 offset:35840
    ds_read_b128 v[48:51], v2 offset:36864
    ds_read_b128 v[52:55], v2 offset:37888
    ds_read_b128 v[56:59], v2 offset:38912
    ds_read_b128 v[60:63], v2 offset:39936
    s_waitcnt lgkmcnt(7)
    v_mfma_f32_32x32x16_bf16 v[16:31], v[224:227], v[32:35], v[16:31]
    s_waitcnt lgkmcnt(6)
    v_mfma_f32_32x32x16_bf16 v[16:31], v[228:231], v[36:39], v[16:31]
    s_waitcnt lgkmcnt(5)
    v_mfma_f32_32x32x16_bf16 v[16:31], v[232:235], v[40:43], v[16:31]
    s_waitcnt lgkmcnt(4)
    v_mfma_f32_32x32x16_bf16 v[16:31], v[236:239], v[44:47], v[16:31]
    s_waitcnt lgkmcnt(3)
    v_mfma_f32_32x32x16_bf16 v[16:31], v[240:243], v[48:51], v[16:31]
    s_waitcnt lgkmcnt(2)
    v_mfma_f32_32x32x16_bf16 v[16:31], v[244:247], v[52:55], v[16:31]
    s_waitcnt lgkmcnt(1)
    v_mfma_f32_32x32x16_bf16 v[16:31], v[248:251], v[56:59], v[16:31]
    s_waitcnt lgkmcnt(0)
    v_mfma_f32_32x32x16_bf16 v[16:31], v[252:255], v[60:63], v[16:31]
    s_cmp_eq_u32 s3, 5
    s_cbranch_scc1 L_p1_kpath
    s_lshl_b32 s24, s3, 11
    s_add_u32 s24, s24, 49152
    v_add_u32 v8, s24, v2
    s_mov_b32 s25, 0x3ea52b5c
    s_nop 6
    v_mul_f32 v16, s25, v16
    v_mul_f32 v17, s25, v17
    v_mul_f32 v18, s25, v18
    v_mul_f32 v19, s25, v19
    v_mul_f32 v20, s25, v20
    v_mul_f32 v21, s25, v21
    v_mul_f32 v22, s25, v22
    v_mul_f32 v23, s25, v23
    v_mul_f32 v24, s25, v24
    v_mul_f32 v25, s25, v25
    v_mul_f32 v26, s25, v26
    v_mul_f32 v27, s25, v27
    v_mul_f32 v28, s25, v28
    v_mul_f32 v29, s25, v29
    v_mul_f32 v30, s25, v30
    v_mul_f32 v31, s25, v31
    v_cvt_pk_bf16_f32 v40, v16, v17
    v_cvt_pk_bf16_f32 v41, v18, v19
    v_cvt_pk_bf16_f32 v42, v20, v21
    v_cvt_pk_bf16_f32 v43, v22, v23
    v_cvt_pk_bf16_f32 v44, v24, v25
    v_cvt_pk_bf16_f32 v45, v26, v27
    v_cvt_pk_bf16_f32 v46, v28, v29
    v_cvt_pk_bf16_f32 v47, v30, v31
    ds_write_b128 v8, v[40:43]
    ds_write_b128 v8, v[44:47] offset:1024
    s_waitcnt lgkmcnt(0)
    s_branch L_p1_done
L_p1_kpath:
    s_lshr_b32 s24, s23, 2
    s_mul_i32 s24, s24, 10240
    s_add_u32 s24, s24, 589824
    s_and_b32 s25, s23, 3
    s_lshl_b32 s26, s25, 10
    s_add_u32 s26, s26, s24
    s_lshl_b32 s27, s25, 8
    s_add_u32 s27, s27, s24
    s_add_u32 s27, s27, 4096
    v_lshlrev_b32 v54, 3, v1
    v_cmp_gt_u32 vcc, 32, v1
    v_cvt_pk_bf16_f32 v40, v16, v17
    v_cvt_pk_bf16_f32 v41, v18, v19
    v_cvt_pk_bf16_f32 v42, v20, v21
    v_cvt_pk_bf16_f32 v43, v22, v23
    v_cvt_pk_bf16_f32 v44, v24, v25
    v_cvt_pk_bf16_f32 v45, v26, v27
    buffer_store_dwordx4 v[40:43], v2, s[4:7], s26 offen sc1
    v_cndmask_b32 v44, 0, v44, vcc
    v_cndmask_b32 v45, 0, v45, vcc
    v_dot2_f32_bf16 v48, v40, v40, 0
    v_dot2_f32_bf16 v49, v41, v41, 0
    v_dot2_f32_bf16 v50, v42, v42, 0
    v_dot2_f32_bf16 v51, v43, v43, 0
    v_dot2_f32_bf16 v52, v44, v44, 0
    v_dot2_f32_bf16 v53, v45, v45, 0
    s_mov_b32 exec_hi, 0
    buffer_store_dwordx2 v[44:45], v54, s[4:7], s27 offen sc1
    s_mov_b32 exec_hi, -1
    v_add_f32 v48, v48, v49
    v_add_f32 v50, v50, v51
    v_add_f32 v52, v52, v53
    v_add_f32 v48, v48, v50
    v_add_f32 v48, v48, v52
    v_mov_b32 v49, v48
    s_nop 1
    v_permlane32_swap_b32 v48, v49
    v_add_f32 v48, v48, v49
    s_nop 1
    v_max_f32_dpp v48, v48, v48 quad_perm:[1,0,3,2] row_mask:0xf bank_mask:0xf
    s_nop 1
    v_max_f32_dpp v48, v48, v48 quad_perm:[2,3,0,1] row_mask:0xf bank_mask:0xf
    s_nop 1
    v_max_f32_dpp v48, v48, v48 row_half_mirror row_mask:0xf bank_mask:0xf
    s_nop 1
    v_max_f32_dpp v48, v48, v48 row_mirror row_mask:0xf bank_mask:0xf
    s_nop 0
    v_readlane_b32 s24, v48, 16
    v_readlane_b32 s26, v48, 0
    v_mov_b32 v49, 163812
    v_mov_b32 v48, s24
    v_max_f32 v48, s26, v48
    s_mov_b64 exec, 1
    ds_max_u32 v49, v48
    s_mov_b64 exec, -1
    s_branch L_p1_sig
L_p1_vpath:
    ds_read_b128 v[32:35], v2 offset:0
    ds_read_b128 v[36:39], v2 offset:1024
    ds_read_b128 v[40:43], v2 offset:2048
    ds_read_b128 v[44:47], v2 offset:3072
    ds_read_b128 v[48:51], v2 offset:4096
    ds_read_b128 v[52:55], v2 offset:5120
    ds_read_b128 v[56:59], v2 offset:6144
    ds_read_b128 v[60:63], v2 offset:7168
    s_waitcnt lgkmcnt(7)
    v_mfma_f32_32x32x16_bf16 v[16:31], v[32:35], v[96:99], 0
    s_waitcnt lgkmcnt(6)
    v_mfma_f32_32x32x16_bf16 v[16:31], v[36:39], v[100:103], v[16:31]
    s_waitcnt lgkmcnt(5)
    v_mfma_f32_32x32x16_bf16 v[16:31], v[40:43], v[104:107], v[16:31]
    s_waitcnt lgkmcnt(4)
    v_mfma_f32_32x32x16_bf16 v[16:31], v[44:47], v[108:111], v[16:31]
    s_waitcnt lgkmcnt(3)
    v_mfma_f32_32x32x16_bf16 v[16:31], v[48:51], v[112:115], v[16:31]
    s_waitcnt lgkmcnt(2)
    v_mfma_f32_32x32x16_bf16 v[16:31], v[52:55], v[116:119], v[16:31]
    s_waitcnt lgkmcnt(1)
    v_mfma_f32_32x32x16_bf16 v[16:31], v[56:59], v[120:123], v[16:31]
    s_waitcnt lgkmcnt(0)
    v_mfma_f32_32x32x16_bf16 v[16:31], v[60:63], v[124:127], v[16:31]
    ds_read_b128 v[64:67], v2 offset:8192
    ds_read_b128 v[68:71], v2 offset:9216
    ds_read_b128 v[72:75], v2 offset:10240
    ds_read_b128 v[76:79], v2 offset:11264
    ds_read_b128 v[80:83], v2 offset:12288
    ds_read_b128 v[84:87], v2 offset:13312
    ds_read_b128 v[88:91], v2 offset:14336
    ds_read_b128 v[92:95], v2 offset:15360
    s_waitcnt lgkmcnt(7)
    v_mfma_f32_32x32x16_bf16 v[16:31], v[64:67], v[128:131], v[16:31]
    s_waitcnt lgkmcnt(6)
    v_mfma_f32_32x32x16_bf16 v[16:31], v[68:71], v[132:135], v[16:31]
    s_waitcnt lgkmcnt(5)
    v_mfma_f32_32x32x16_bf16 v[16:31], v[72:75], v[136:139], v[16:31]
    s_waitcnt lgkmcnt(4)
    v_mfma_f32_32x32x16_bf16 v[16:31], v[76:79], v[140:143], v[16:31]
    s_waitcnt lgkmcnt(3)
    v_mfma_f32_32x32x16_bf16 v[16:31], v[80:83], v[144:147], v[16:31]
    s_waitcnt lgkmcnt(2)
    v_mfma_f32_32x32x16_bf16 v[16:31], v[84:87], v[148:151], v[16:31]
    s_waitcnt lgkmcnt(1)
    v_mfma_f32_32x32x16_bf16 v[16:31], v[88:91], v[152:155], v[16:31]
    s_waitcnt lgkmcnt(0)
    v_mfma_f32_32x32x16_bf16 v[16:31], v[92:95], v[156:159], v[16:31]
    ds_read_b128 v[32:35], v2 offset:16384
    ds_read_b128 v[36:39], v2 offset:17408
    ds_read_b128 v[40:43], v2 offset:18432
    ds_read_b128 v[44:47], v2 offset:19456
    ds_read_b128 v[48:51], v2 offset:20480
    ds_read_b128 v[52:55], v2 offset:21504
    ds_read_b128 v[56:59], v2 offset:22528
    ds_read_b128 v[60:63], v2 offset:23552
    s_waitcnt lgkmcnt(7)
    v_mfma_f32_32x32x16_bf16 v[16:31], v[32:35], v[160:163], v[16:31]
    s_waitcnt lgkmcnt(6)
    v_mfma_f32_32x32x16_bf16 v[16:31], v[36:39], v[164:167], v[16:31]
    s_waitcnt lgkmcnt(5)
    v_mfma_f32_32x32x16_bf16 v[16:31], v[40:43], v[168:171], v[16:31]
    s_waitcnt lgkmcnt(4)
    v_mfma_f32_32x32x16_bf16 v[16:31], v[44:47], v[172:175], v[16:31]
    s_waitcnt lgkmcnt(3)
    v_mfma_f32_32x32x16_bf16 v[16:31], v[48:51], v[176:179], v[16:31]
    s_waitcnt lgkmcnt(2)
    v_mfma_f32_32x32x16_bf16 v[16:31], v[52:55], v[180:183], v[16:31]
    s_waitcnt lgkmcnt(1)
    v_mfma_f32_32x32x16_bf16 v[16:31], v[56:59], v[184:187], v[16:31]
    s_waitcnt lgkmcnt(0)
    v_mfma_f32_32x32x16_bf16 v[16:31], v[60:63], v[188:191], v[16:31]
    ds_read_b128 v[64:67], v2 offset:24576
    ds_read_b128 v[68:71], v2 offset:25600
    ds_read_b128 v[72:75], v2 offset:26624
    ds_read_b128 v[76:79], v2 offset:27648
    ds_read_b128 v[80:83], v2 offset:28672
    ds_read_b128 v[84:87], v2 offset:29696
    ds_read_b128 v[88:91], v2 offset:30720
    ds_read_b128 v[92:95], v2 offset:31744
    s_waitcnt lgkmcnt(7)
    v_mfma_f32_32x32x16_bf16 v[16:31], v[64:67], v[192:195], v[16:31]
    s_waitcnt lgkmcnt(6)
    v_mfma_f32_32x32x16_bf16 v[16:31], v[68:71], v[196:199], v[16:31]
    s_waitcnt lgkmcnt(5)
    v_mfma_f32_32x32x16_bf16 v[16:31], v[72:75], v[200:203], v[16:31]
    s_waitcnt lgkmcnt(4)
    v_mfma_f32_32x32x16_bf16 v[16:31], v[76:79], v[204:207], v[16:31]
    s_waitcnt lgkmcnt(3)
    v_mfma_f32_32x32x16_bf16 v[16:31], v[80:83], v[208:211], v[16:31]
    s_waitcnt lgkmcnt(2)
    v_mfma_f32_32x32x16_bf16 v[16:31], v[84:87], v[212:215], v[16:31]
    s_waitcnt lgkmcnt(1)
    v_mfma_f32_32x32x16_bf16 v[16:31], v[88:91], v[216:219], v[16:31]
    s_waitcnt lgkmcnt(0)
    v_mfma_f32_32x32x16_bf16 v[16:31], v[92:95], v[220:223], v[16:31]
    ds_read_b128 v[32:35], v2 offset:32768
    ds_read_b128 v[36:39], v2 offset:33792
    ds_read_b128 v[40:43], v2 offset:34816
    ds_read_b128 v[44:47], v2 offset:35840
    ds_read_b128 v[48:51], v2 offset:36864
    ds_read_b128 v[52:55], v2 offset:37888
    ds_read_b128 v[56:59], v2 offset:38912
    ds_read_b128 v[60:63], v2 offset:39936
    s_waitcnt lgkmcnt(7)
    v_mfma_f32_32x32x16_bf16 v[16:31], v[32:35], v[224:227], v[16:31]
    s_waitcnt lgkmcnt(6)
    v_mfma_f32_32x32x16_bf16 v[16:31], v[36:39], v[228:231], v[16:31]
    s_waitcnt lgkmcnt(5)
    v_mfma_f32_32x32x16_bf16 v[16:31], v[40:43], v[232:235], v[16:31]
    s_waitcnt lgkmcnt(4)
    v_mfma_f32_32x32x16_bf16 v[16:31], v[44:47], v[236:239], v[16:31]
    s_waitcnt lgkmcnt(3)
    v_mfma_f32_32x32x16_bf16 v[16:31], v[48:51], v[240:243], v[16:31]
    s_waitcnt lgkmcnt(2)
    v_mfma_f32_32x32x16_bf16 v[16:31], v[52:55], v[244:247], v[16:31]
    s_waitcnt lgkmcnt(1)
    v_mfma_f32_32x32x16_bf16 v[16:31], v[56:59], v[248:251], v[16:31]
    s_waitcnt lgkmcnt(0)
    v_mfma_f32_32x32x16_bf16 v[16:31], v[60:63], v[252:255], v[16:31]
    s_lshr_b32 s24, s23, 2
    s_mul_i32 s24, s24, 10240
    s_and_b32 s25, s23, 3
    s_mul_i32 s25, s25, 1280
    s_add_u32 s24, s24, s25
    s_add_u32 s24, s24, 594944
    v_and_b32 v48, 19, v3
    v_bfe_u32 v49, v3, 2, 1
    v_lshl_add_u32 v48, v49, 3, v48
    v_bfe_u32 v49, v3, 3, 1
    v_lshl_add_u32 v48, v49, 2, v48
    v_cmp_gt_u32 vcc, 20, v48
    v_add_u32 v48, 6, v48
    v_subrev_u32 v49, 20, v48
    v_min_u32 v48, v48, v49
    v_mul_u32_u24 v49, 20, v4
    v_add_lshl_u32 v48, v48, v49, 4
    v_cvt_pk_bf16_f32 v40, v16, v17
    v_cvt_pk_bf16_f32 v41, v18, v19
    v_cvt_pk_bf16_f32 v42, v20, v21
    v_cvt_pk_bf16_f32 v43, v22, v23
    v_cvt_pk_bf16_f32 v44, v24, v25
    v_cvt_pk_bf16_f32 v45, v26, v27
    v_cvt_pk_bf16_f32 v46, v28, v29
    v_cvt_pk_bf16_f32 v47, v30, v31
    s_and_saveexec_b64 s[26:27], vcc
    buffer_store_dwordx4 v[40:43], v48, s[4:7], s24 offen sc1
    buffer_store_dwordx4 v[44:47], v48, s[4:7], s24 offen offset:640 sc1
    s_mov_b64 exec, -1
L_p1_sig:
    v_mov_b32 v52, 163780
    v_mov_b32 v53, 1
    s_mov_b64 exec, 1
    s_waitcnt vmcnt(0)
    ds_add_rtn_u32 v54, v52, v53
    ds_read_b32 v55, v52 offset:32
    s_waitcnt lgkmcnt(0)
    v_readfirstlane_b32 s74, v54
    v_readfirstlane_b32 s73, v55
    s_cmp_lg_u32 s74, 1
    s_cbranch_scc1 L_p1_nosig
    s_mov_b64 exec, 0xff
    s_lshl_b32 s74, s68, 7
    s_add_u32 s74, s74, 262144
    v_mov_b32 v52, s76
    v_mov_b32 v53, s77
    v_mov_b32 v54, s73
    v_mov_b32 v55, 0
    buffer_store_dwordx4 v[52:55], v2, s[4:7], s74 offen sc1
L_p1_nosig:
    s_mov_b64 exec, -1
    s_setprio 0
L_p1_done:
    s_and_b32 s20, s67, 7
    s_lshl_b32 s21, s66, 3
    s_add_u32 s20, s20, s21
    s_lshr_b32 s21, s67, 3
    s_and_b32 s22, s3, 3
    s_lshr_b32 s23, s3, 2
    s_lshl_b32 s24, s21, 3
    s_lshl_b32 s25, s22, 1
    s_add_u32 s24, s24, s25
    s_mov_b32 s25, s24
    s_add_u32 s26, s24, 1
    v_lshlrev_b32 v172, 4, v3
    v_add_u32 v172, 49152, v172
    v_lshlrev_b32 v173, 7, v1
    s_mov_b32 s30, 32768
    s_mul_i32 s31, s23, 81920
    s_mul_i32 s32, s22, 5120
    s_add_u32 s31, s31, s32
    s_add_u32 s32, s31, 589824
    s_mov_b32 s8, s44
    s_mov_b32 s9, s45
    s_mov_b32 s10, 819200
    s_mov_b32 s11, 0x20000
    s_mov_b32 s12, s48
    s_mov_b32 s13, s49
    s_mov_b32 s14, 2211840
    s_mov_b32 s15, 0x20000
    s_mov_b32 s16, s52
    s_mov_b32 s17, s53
    s_mov_b32 s18, 2211840
    s_mov_b32 s19, 0x20000
    s_cmp_lg_u32 s3, 7
    s_cbranch_scc1 L_p2_warmed
    v_mov_b32 v164, v2
    v_mov_b32 v165, v2
    v_mov_b32 v196, v2
    s_mov_b32 s68, 0x0033ffff
    s_mov_b32 s69, 0x0033ffff
    s_mov_b32 s34, 0
    s_mov_b32 s35, 7
    s_mov_b32 s79, 1
    s_branch L_p2_loop
L_p2_warm_ret:
    s_nop 7
    s_nop 7
L_p2_warmed:
    s_mov_b32 s79, 0
    s_and_b32 s28, s25, 7
    s_mul_i32 s28, s28, 5
    v_lshl_add_u32 v166, v4, 1, s28
    v_lshrrev_b32 v180, 1, v166
    v_lshl_add_u32 v180, v180, 9, v172
    v_and_b32 v166, 1, v166
    v_lshl_add_u32 v180, v166, 3, v180
    v_lshl_add_u32 v166, v4, 1, s28
    v_add_u32 v166, 1, v166
    v_lshrrev_b32 v181, 1, v166
    v_lshl_add_u32 v181, v181, 9, v172
    v_and_b32 v166, 1, v166
    v_lshl_add_u32 v181, v166, 3, v181
    s_add_u32 s29, s28, 4
    v_mov_b32 v166, s29
    v_lshrrev_b32 v182, 1, v166
    v_lshl_add_u32 v182, v182, 9, v172
    v_and_b32 v166, 1, v166
    v_lshl_add_u32 v182, v166, 3, v182
    s_and_b32 s28, s26, 7
    s_mul_i32 s28, s28, 5
    v_lshl_add_u32 v166, v4, 1, s28
    v_lshrrev_b32 v183, 1, v166
    v_lshl_add_u32 v183, v183, 9, v172
    v_and_b32 v166, 1, v166
    v_lshl_add_u32 v183, v166, 3, v183
    v_lshl_add_u32 v166, v4, 1, s28
    v_add_u32 v166, 1, v166
    v_lshrrev_b32 v184, 1, v166
    v_lshl_add_u32 v184, v184, 9, v172
    v_and_b32 v166, 1, v166
    v_lshl_add_u32 v184, v166, 3, v184
    s_add_u32 s29, s28, 4
    v_mov_b32 v166, s29
    v_lshrrev_b32 v185, 1, v166
    v_lshl_add_u32 v185, v185, 9, v172
    v_and_b32 v166, 1, v166
    v_lshl_add_u32 v185, v166, 3, v185
    s_mul_i32 s34, s23, 81920
    v_add_u32 v164, s34, v2
    v_lshl_add_u32 v196, v1, 3, s34
    v_bfe_u32 v167, v3, 2, 1
    v_mul_u32_u24 v167, 10, v167
    v_lshrrev_b32 v168, 3, v3
    v_lshl_add_u32 v167, v168, 2, v167
    v_and_b32 v168, 3, v3
    v_add3_u32 v167, v167, v168, 6
    v_subrev_u32 v168, 20, v167
    v_min_u32 v167, v167, v168
    v_mul_u32_u24 v168, 20, v4
    v_add_lshl_u32 v167, v167, v168, 4
    s_add_u32 s34, s34, 5120
    v_add_u32 v165, s34, v167
    v_and_b32 v167, 27, v3
    v_cmp_eq_u32 vcc, 18, v167
    v_mov_b32 v168, 0x3f803f80
    s_nop 0
    v_cndmask_b32 v148, 0, v168, vcc
    v_mov_b32 v149, v148
    v_mov_b32 v150, v148
    v_mov_b32 v151, v148
    v_mov_b32 v152, v148
    v_mov_b32 v153, v148
    v_mov_b32 v154, v148
    v_mov_b32 v155, v148
    v_mov_b32 v156, v148
    v_mov_b32 v157, v148
    v_mov_b32 v158, v148
    v_mov_b32 v159, v148
    v_mov_b32 v160, v148
    v_mov_b32 v161, v148
    v_mov_b32 v162, v148
    v_mov_b32 v163, v148
    v_mov_b32 v56, 0
    v_mov_b32 v57, 0
    v_mov_b32 v58, 0
    v_mov_b32 v59, 0
    v_mov_b32 v60, 0
    v_mov_b32 v61, 0
    v_mov_b32 v62, 0
    v_mov_b32 v63, 0
    v_mov_b32 v64, 0
    v_mov_b32 v65, 0
    v_mov_b32 v66, 0
    v_mov_b32 v67, 0
    v_mov_b32 v68, 0
    v_mov_b32 v69, 0
    v_mov_b32 v70, 0
    v_mov_b32 v71, 0
    v_mov_b32 v72, 0
    v_mov_b32 v73, 0
    v_mov_b32 v74, 0
    v_mov_b32 v75, 0
    v_mov_b32 v76, 0
    v_mov_b32 v77, 0
    v_mov_b32 v78, 0
    v_mov_b32 v79, 0
    v_mov_b32 v80, 0
    v_mov_b32 v81, 0
    v_mov_b32 v82, 0
    v_mov_b32 v83, 0
    v_mov_b32 v84, 0
    v_mov_b32 v85, 0
    v_mov_b32 v86, 0
    v_mov_b32 v87, 0
    v_mov_b32 v128, 0
    v_mov_b32 v129, 0
    v_mov_b32 v130, 0
    v_mov_b32 v131, 0
    v_mov_b32 v132, 0
    v_mov_b32 v133, 0
    v_mov_b32 v134, 0
    v_mov_b32 v135, 0
    v_mov_b32 v118, 0
    v_mov_b32 v119, 0
    s_and_b32 s68, s2, 0xf8
    s_add_u32 s68, s68, s22
    s_and_b32 s69, s2, 1
    s_mov_b32 s70, 1280
    s_mov_b32 s71, 3456
    v_lshrrev_b32 v166, 3, v1
    v_and_b32 v167, 7, v1
    v_min_u32 v167, 4, v167
    v_lshlrev_b32 v167, 7, v167
    v_min_u32 v168, 6, v166
    v_mad_u32_u24 v176, v168, s70, v167
    s_mul_i32 s72, s68, 8960
    s_mul_i32 s73, s69, 640
    s_add_u32 s72, s72, s73
    v_add_u32 v176, s72, v176
    v_min_u32 v168, 2, v166
    v_mad_u32_u24 v177, v168, s70, v167
    s_mul_i32 s72, s68, 3840
    s_add_u32 s72, s72, s73
    v_add_u32 v177, s72, v177
    v_lshrrev_b32 v166, 4, v1
    v_min_u32 v166, 2, v166
    v_and_b32 v167, 15, v1
    v_min_u32 v167, 13, v167
    v_lshlrev_b32 v167, 7, v167
    v_mad_u32_u24 v178, v166, s71, v167
    s_mul_i32 s72, s68, 10368
    s_mul_i32 s73, s69, 1792
    s_add_u32 s72, s72, s73
    v_add_u32 v178, s72, v178
    s_mov_b32 s68, 0x0033ffff
    s_mov_b32 s69, 0x0033ffff
    s_barrier
    ds_read_b64 v[8:9], v180
    ds_read_b64 v[10:11], v181
    ds_read_b64 v[16:17], v182
    ds_read_b64 v[12:13], v183
    ds_read_b64 v[14:15], v184
    ds_read_b64 v[20:21], v185
    v_cmp_gt_u32 vcc, 32, v1
    s_nop 0
    s_waitcnt lgkmcnt(0)
    v_cndmask_b32 v18, v16, 0, vcc
    v_cndmask_b32 v19, v17, 0, vcc
    v_cndmask_b32 v16, 0, v16, vcc
    v_cndmask_b32 v17, 0, v17, vcc
    v_cndmask_b32 v22, v20, 0, vcc
    v_cndmask_b32 v23, v21, 0, vcc
    v_cndmask_b32 v20, 0, v20, vcc
    v_cndmask_b32 v21, 0, v21, vcc
    v_dot2_f32_bf16 v167, v8, v8, 0
    v_dot2_f32_bf16 v168, v9, v9, 0
    v_dot2_f32_bf16 v169, v16, v16, 0
    s_nop 0
    v_dot2_f32_bf16 v167, v10, v10, v167
    v_dot2_f32_bf16 v168, v11, v11, v168
    v_dot2_f32_bf16 v169, v17, v17, v169
    v_dot2_f32_bf16 v170, v12, v12, 0
    v_dot2_f32_bf16 v171, v13, v13, 0
    v_dot2_f32_bf16 v172, v20, v20, 0
    s_nop 0
    v_dot2_f32_bf16 v170, v14, v14, v170
    v_dot2_f32_bf16 v171, v15, v15, v171
    v_dot2_f32_bf16 v172, v21, v21, v172
    s_nop 2
    v_add_f32 v167, v167, v168
    v_add_f32 v170, v170, v171
    v_add_f32 v167, v167, v169
    v_add_f32 v170, v170, v172
    v_mov_b32 v168, v167
    s_nop 1
    v_permlane32_swap_b32 v167, v168
    v_add_f32 v167, v167, v168
    v_mov_b32 v171, v170
    s_nop 1
    v_permlane32_swap_b32 v170, v171
    v_add_f32 v170, v170, v171
    s_cmp_lg_u32 s3, 7
    s_cbranch_scc1 L_p2_go
    v_add_u32 v180, 128, v1
    v_lshlrev_b32 v180, 7, v180
    s_mov_b32 s74, 0
    s_mov_b32 s75, 262144
L_p2x_poll:
    buffer_load_dwordx4 v[182:185], v180, s[4:7], s75 offen sc1
    s_add_u32 s74, s74, 1
    s_waitcnt vmcnt(0)
    v_cmp_ne_u64 vcc, s[76:77], v[182:183]
    s_cmp_gt_u32 s74, 400000
    s_cbranch_scc1 L_p2x_go
    s_nop 2
    s_cbranch_vccz L_p2x_go
    s_sleep 1
    s_branch L_p2x_poll
L_p2x_go:
    s_nop 1
    v_max_f32_dpp v184, v184, v184 quad_perm:[1,0,3,2] row_mask:0xf bank_mask:0xf
    s_nop 1
    v_max_f32_dpp v184, v184, v184 quad_perm:[2,3,0,1] row_mask:0xf bank_mask:0xf
    s_nop 1
    v_max_f32_dpp v184, v184, v184 row_half_mirror row_mask:0xf bank_mask:0xf
    s_nop 1
    v_max_f32_dpp v184, v184, v184 row_mirror row_mask:0xf bank_mask:0xf
    s_nop 0
    v_readlane_b32 s70, v184, 16
    v_readlane_b32 s71, v184, 32
    v_readlane_b32 s72, v184, 48
    v_mov_b32 v180, 150000
    v_max_f32 v184, s70, v184
    v_max_f32 v184, s71, v184
    v_max_f32 v184, s72, v184
    s_mov_b64 exec, 1
    ds_write_b32 v180, v184
    s_mov_b64 exec, -1
    s_waitcnt lgkmcnt(0)
L_p2_go:
    v_mov_b32 v173, 150000
    s_barrier
    ds_read_b32 v174, v173
    s_add_u32 m0, s31, 0
    s_add_u32 s33, s32, 0
    buffer_load_dwordx4 v2, s[4:7], s33 offen sc1 lds
    s_add_u32 m0, s31, 1024
    s_add_u32 s33, s32, 1024
    buffer_load_dwordx4 v2, s[4:7], s33 offen sc1 lds
    s_add_u32 m0, s31, 2048
    s_add_u32 s33, s32, 2048
    buffer_load_dwordx4 v2, s[4:7], s33 offen sc1 lds
    s_add_u32 m0, s31, 3072
    s_add_u32 s33, s32, 3072
    buffer_load_dwordx4 v2, s[4:7], s33 offen sc1 lds
    s_add_u32 m0, s31, 4096
    s_add_u32 s33, s32, 4096
    buffer_load_dwordx4 v2, s[4:7], s33 offen sc1 lds
    s_add_u32 s31, s31, 20480
    s_add_u32 s32, s32, 20480
    s_waitcnt lgkmcnt(0)
    v_mul_f32 v167, v167, v174
    v_mul_f32 v170, v170, v174
    v_sqrt_f32 v167, v167
    v_sqrt_f32 v170, v170
    s_nop 0
    v_mul_f32 v24, 0xbf808000, v167
    v_mul_f32 v40, 0xbf808000, v170
    v_mov_b32 v25, v24
    v_mov_b32 v41, v40
    v_mov_b32 v26, v24
    v_mov_b32 v42, v40
    v_mov_b32 v27, v24
    v_mov_b32 v43, v40
    v_mov_b32 v28, v24
    v_mov_b32 v44, v40
    v_mov_b32 v29, v24
    v_mov_b32 v45, v40
    v_mov_b32 v30, v24
    v_mov_b32 v46, v40
    v_mov_b32 v31, v24
    v_mov_b32 v47, v40
    v_mov_b32 v32, v24
    v_mov_b32 v48, v40
    v_mov_b32 v33, v24
    v_mov_b32 v49, v40
    v_mov_b32 v34, v24
    v_mov_b32 v50, v40
    v_mov_b32 v35, v24
    v_mov_b32 v51, v40
    v_mov_b32 v36, v24
    v_mov_b32 v52, v40
    v_mov_b32 v37, v24
    v_mov_b32 v53, v40
    v_mov_b32 v38, v24
    v_mov_b32 v54, v40
    v_mov_b32 v39, v24
    v_mov_b32 v55, v40
    s_waitcnt vmcnt(0)
    s_barrier
    s_mov_b32 s34, 86
    s_setprio 3
    s_cmp_lt_u32 s3, 4
    s_cbranch_scc1 L_p2_old
    s_mul_i32 s31, s22, 5120
    s_add_u32 s31, s31, 20480
    s_mov_b32 s28, 0
L_p2_kvl:
    s_add_u32 m0, s31, 0
    s_add_u32 s33, s31, 589824
    buffer_load_dwordx4 v2, s[4:7], s33 offen sc1 lds
    s_add_u32 m0, s31, 1024
    s_add_u32 s33, s31, 590848
    buffer_load_dwordx4 v2, s[4:7], s33 offen sc1 lds
    s_add_u32 m0, s31, 2048
    s_add_u32 s33, s31, 591872
    buffer_load_dwordx4 v2, s[4:7], s33 offen sc1 lds
    s_add_u32 m0, s31, 3072
    s_add_u32 s33, s31, 592896
    buffer_load_dwordx4 v2, s[4:7], s33 offen sc1 lds
    s_add_u32 m0, s31, 4096
    s_add_u32 s33, s31, 593920
    buffer_load_dwordx4 v2, s[4:7], s33 offen sc1 lds
    s_add_u32 m0, s31, 81920
    s_add_u32 s33, s31, 671744
    buffer_load_dwordx4 v2, s[4:7], s33 offen sc1 lds
    s_add_u32 m0, s31, 82944
    s_add_u32 s33, s31, 672768
    buffer_load_dwordx4 v2, s[4:7], s33 offen sc1 lds
    s_add_u32 m0, s31, 83968
    s_add_u32 s33, s31, 673792
    buffer_load_dwordx4 v2, s[4:7], s33 offen sc1 lds
    s_add_u32 m0, s31, 84992
    s_add_u32 s33, s31, 674816
    buffer_load_dwordx4 v2, s[4:7], s33 offen sc1 lds
    s_add_u32 m0, s31, 86016
    s_add_u32 s33, s31, 675840
    buffer_load_dwordx4 v2, s[4:7], s33 offen sc1 lds
    s_add_u32 s31, s31, 20480
    s_add_u32 s28, s28, 1
    s_cmp_lt_u32 s28, 3
    s_cbranch_scc1 L_p2_kvl
    s_waitcnt vmcnt(0)
    s_barrier
    s_barrier
    s_mov_b32 s34, 84
    s_mov_b32 s70, 15360
    buffer_load_dword v179, v177, s[8:11], 0 offen offset:0
    buffer_load_dword v179, v177, s[8:11], 0 offen offset:64
    buffer_load_dword v179, v177, s[8:11], s70 offen offset:0
    buffer_load_dword v179, v177, s[8:11], s70 offen offset:64
    s_mov_b32 s70, 41472
    buffer_load_dword v179, v178, s[12:15], 0 offen offset:0
    buffer_load_dword v179, v178, s[12:15], 0 offen offset:64
    buffer_load_dword v179, v178, s[12:15], s70 offen offset:0
    buffer_load_dword v179, v178, s[12:15], s70 offen offset:64
    s_mov_b32 s70, 35840
    buffer_load_dword v179, v176, s[16:19], 0 offen offset:0
    buffer_load_dword v179, v176, s[16:19], 0 offen offset:64
    buffer_load_dword v179, v176, s[16:19], s70 offen offset:0
    buffer_load_dword v179, v176, s[16:19], s70 offen offset:64
    s_cmp_lg_u32 s3, 7
    s_cbranch_scc1 L_p2_old
    s_mov_b32 s28, s62
    s_mov_b32 s29, s63
    s_mov_b32 s30, 256
    s_mov_b32 s31, 0x20000
    v_mov_b32 v166, 0
    v_mov_b32 v180, 1
    s_mov_b64 exec, 1
    buffer_atomic_add v180, v166, s[28:31], 0 offen offset:252 sc0 sc1
    s_mov_b64 exec, -1
L_p2_old:
    ds_read_b128 v[136:139], v164 offset:0
    ds_read_b64 v[144:145], v196 offset:4096
    s_waitcnt lgkmcnt(0)
    v_mfma_f32_32x32x16_bf16 v[88:103], v[136:139], v[8:11], v[24:39]
    v_mfma_f32_32x32x8_bf16 v[88:103], v[144:145], v[16:17], v[88:103]
    s_mov_b32 s35, 0
    s_nop 7
    s_nop 3
L_p2_loop:
    s_bitcmp1_b32 s34, s35
    s_cbranch_scc1 L_p2_bar
L_p2_body:
    v_exp_f32 v88, v88
    v_cvt_pk_bf16_f32 v135, v118, v119
    v_mfma_f32_32x32x16_bf16 v[104:119], v[136:139], v[12:15], v[40:55]
    v_exp_f32 v89, v89
    v_exp_f32 v90, v90
    v_exp_f32 v91, v91
    v_cvt_pk_bf16_f32 v120, v88, v89
    v_exp_f32 v92, v92
    v_exp_f32 v93, v93
    v_mfma_f32_32x32x8_bf16 v[104:119], v[144:145], v[20:21], v[104:119]
    ds_read_b128 v[140:143], v164 offset:1024
    ds_read_b64 v[146:147], v196 offset:4608
    v_cvt_pk_bf16_f32 v121, v90, v91
    v_exp_f32 v94, v94
    v_exp_f32 v95, v95
    v_cvt_pk_bf16_f32 v122, v92, v93
    v_exp_f32 v96, v96
    v_exp_f32 v97, v97
    v_mfma_f32_32x32x16_bf16 v[72:87], v[156:159], v[128:131], v[72:87]
    s_mov_b64 exec, s[68:69]
    ds_read_b128 v[148:151], v165 offset:0
    ds_read_b128 v[152:155], v165 offset:640
    s_mov_b64 exec, -1
    v_cvt_pk_bf16_f32 v123, v94, v95
    v_exp_f32 v98, v98
    v_exp_f32 v99, v99
    v_cvt_pk_bf16_f32 v124, v96, v97
    v_exp_f32 v100, v100
    v_exp_f32 v101, v101
    v_mfma_f32_32x32x16_bf16 v[72:87], v[160:163], v[132:135], v[72:87]
    v_cvt_pk_bf16_f32 v125, v98, v99
    v_exp_f32 v102, v102
    v_exp_f32 v103, v103
    v_cvt_pk_bf16_f32 v126, v100, v101
    v_exp_f32 v104, v104
    v_cvt_pk_bf16_f32 v127, v102, v103
    s_waitcnt lgkmcnt(0)
    v_mfma_f32_32x32x16_bf16 v[88:103], v[140:143], v[8:11], v[24:39]
    v_exp_f32 v105, v105
    v_exp_f32 v106, v106
    v_exp_f32 v107, v107
    v_cvt_pk_bf16_f32 v128, v104, v105
    v_exp_f32 v108, v108
    v_exp_f32 v109, v109
    v_mfma_f32_32x32x8_bf16 v[88:103], v[144:145], v[18:19], v[88:103]
    v_cvt_pk_bf16_f32 v129, v106, v107
    v_exp_f32 v110, v110
    v_exp_f32 v111, v111
    v_cvt_pk_bf16_f32 v130, v108, v109
    v_exp_f32 v112, v112
    v_exp_f32 v113, v113
    v_mfma_f32_32x32x16_bf16 v[56:71], v[148:151], v[120:123], v[56:71]
    v_cvt_pk_bf16_f32 v131, v110, v111
    v_exp_f32 v114, v114
    v_exp_f32 v115, v115
    v_cvt_pk_bf16_f32 v132, v112, v113
    v_exp_f32 v116, v116
    v_exp_f32 v117, v117
    v_mfma_f32_32x32x16_bf16 v[56:71], v[152:155], v[124:127], v[56:71]
    v_cvt_pk_bf16_f32 v133, v114, v115
    v_exp_f32 v118, v118
    v_exp_f32 v119, v119
    v_cvt_pk_bf16_f32 v134, v116, v117
    v_exp_f32 v88, v88
    v_cvt_pk_bf16_f32 v135, v118, v119
    v_mfma_f32_32x32x16_bf16 v[104:119], v[140:143], v[12:15], v[40:55]
    v_exp_f32 v89, v89
    v_exp_f32 v90, v90
    v_exp_f32 v91, v91
    v_cvt_pk_bf16_f32 v120, v88, v89
    v_exp_f32 v92, v92
    v_exp_f32 v93, v93
    v_mfma_f32_32x32x8_bf16 v[104:119], v[144:145], v[22:23], v[104:119]
    ds_read_b128 v[136:139], v164 offset:2048
    v_cvt_pk_bf16_f32 v121, v90, v91
    v_exp_f32 v94, v94
    v_exp_f32 v95, v95
    v_cvt_pk_bf16_f32 v122, v92, v93
    v_exp_f32 v96, v96
    v_exp_f32 v97, v97
    v_mfma_f32_32x32x16_bf16 v[72:87], v[148:151], v[128:131], v[72:87]
    s_mov_b64 exec, s[68:69]
    ds_read_b128 v[156:159], v165 offset:1280
    ds_read_b128 v[160:163], v165 offset:1920
    s_mov_b64 exec, -1
    v_cvt_pk_bf16_f32 v123, v94, v95
    v_exp_f32 v98, v98
    v_exp_f32 v99, v99
    v_cvt_pk_bf16_f32 v124, v96, v97
    v_exp_f32 v100, v100
    v_exp_f32 v101, v101
    v_mfma_f32_32x32x16_bf16 v[72:87], v[152:155], v[132:135], v[72:87]
    v_cvt_pk_bf16_f32 v125, v98, v99
    v_exp_f32 v102, v102
    v_exp_f32 v103, v103
    v_cvt_pk_bf16_f32 v126, v100, v101
    v_exp_f32 v104, v104
    v_cvt_pk_bf16_f32 v127, v102, v103
    s_waitcnt lgkmcnt(0)
    v_mfma_f32_32x32x16_bf16 v[88:103], v[136:139], v[8:11], v[24:39]
    v_exp_f32 v105, v105
    v_exp_f32 v106, v106
    v_exp_f32 v107, v107
    v_cvt_pk_bf16_f32 v128, v104, v105
    v_exp_f32 v108, v108
    v_exp_f32 v109, v109
    v_mfma_f32_32x32x8_bf16 v[88:103], v[146:147], v[16:17], v[88:103]
    v_cvt_pk_bf16_f32 v129, v106, v107
    v_exp_f32 v110, v110
    v_exp_f32 v111, v111
    v_cvt_pk_bf16_f32 v130, v108, v109
    v_exp_f32 v112, v112
    v_exp_f32 v113, v113
    v_mfma_f32_32x32x16_bf16 v[56:71], v[156:159], v[120:123], v[56:71]
    v_cvt_pk_bf16_f32 v131, v110, v111
    v_exp_f32 v114, v114
    v_exp_f32 v115, v115
    v_cvt_pk_bf16_f32 v132, v112, v113
    v_exp_f32 v116, v116
    v_exp_f32 v117, v117
    v_mfma_f32_32x32x16_bf16 v[56:71], v[160:163], v[124:127], v[56:71]
    v_cvt_pk_bf16_f32 v133, v114, v115
    v_exp_f32 v118, v118
    v_exp_f32 v119, v119
    v_cvt_pk_bf16_f32 v134, v116, v117
    v_exp_f32 v88, v88
    v_cvt_pk_bf16_f32 v135, v118, v119
    v_mfma_f32_32x32x16_bf16 v[104:119], v[136:139], v[12:15], v[40:55]
    v_exp_f32 v89, v89
    v_exp_f32 v90, v90
    v_exp_f32 v91, v91
    v_cvt_pk_bf16_f32 v120, v88, v89
    v_exp_f32 v92, v92
    v_exp_f32 v93, v93
    v_mfma_f32_32x32x8_bf16 v[104:119], v[146:147], v[20:21], v[104:119]
    ds_read_b128 v[140:143], v164 offset:3072
    ds_read_b64 v[144:145], v196 offset:14336
    v_cvt_pk_bf16_f32 v121, v90, v91
    v_exp_f32 v94, v94
    v_exp_f32 v95, v95
    v_cvt_pk_bf16_f32 v122, v92, v93
    v_exp_f32 v96, v96
    v_exp_f32 v97, v97
    v_mfma_f32_32x32x16_bf16 v[72:87], v[156:159], v[128:131], v[72:87]
    s_mov_b64 exec, s[68:69]
    ds_read_b128 v[148:151], v165 offset:2560
    ds_read_b128 v[152:155], v165 offset:3200
    s_mov_b64 exec, -1
    v_cvt_pk_bf16_f32 v123, v94, v95
    v_exp_f32 v98, v98
    v_exp_f32 v99, v99
    v_cvt_pk_bf16_f32 v124, v96, v97
    v_exp_f32 v100, v100
    v_exp_f32 v101, v101
    v_mfma_f32_32x32x16_bf16 v[72:87], v[160:163], v[132:135], v[72:87]
    v_cvt_pk_bf16_f32 v125, v98, v99
    v_exp_f32 v102, v102
    v_exp_f32 v103, v103
    v_cvt_pk_bf16_f32 v126, v100, v101
    v_exp_f32 v104, v104
    v_cvt_pk_bf16_f32 v127, v102, v103
    s_waitcnt lgkmcnt(0)
    v_mfma_f32_32x32x16_bf16 v[88:103], v[140:143], v[8:11], v[24:39]
    v_exp_f32 v105, v105
    v_exp_f32 v106, v106
    v_exp_f32 v107, v107
    v_cvt_pk_bf16_f32 v128, v104, v105
    v_exp_f32 v108, v108
    v_exp_f32 v109, v109
    v_mfma_f32_32x32x8_bf16 v[88:103], v[146:147], v[18:19], v[88:103]
    v_cvt_pk_bf16_f32 v129, v106, v107
    v_exp_f32 v110, v110
    v_exp_f32 v111, v111
    v_cvt_pk_bf16_f32 v130, v108, v109
    v_exp_f32 v112, v112
    v_exp_f32 v113, v113
    v_mfma_f32_32x32x16_bf16 v[56:71], v[148:151], v[120:123], v[56:71]
    v_cvt_pk_bf16_f32 v131, v110, v111
    v_exp_f32 v114, v114
    v_exp_f32 v115, v115
    v_cvt_pk_bf16_f32 v132, v112, v113
    v_exp_f32 v116, v116
    v_exp_f32 v117, v117
    v_mfma_f32_32x32x16_bf16 v[56:71], v[152:155], v[124:127], v[56:71]
    v_cvt_pk_bf16_f32 v133, v114, v115
    v_exp_f32 v118, v118
    v_exp_f32 v119, v119
    v_cvt_pk_bf16_f32 v134, v116, v117
    v_exp_f32 v88, v88
    v_cvt_pk_bf16_f32 v135, v118, v119
    v_mfma_f32_32x32x16_bf16 v[104:119], v[140:143], v[12:15], v[40:55]
    v_exp_f32 v89, v89
    v_exp_f32 v90, v90
    v_exp_f32 v91, v91
    v_cvt_pk_bf16_f32 v120, v88, v89
    v_exp_f32 v92, v92
    v_exp_f32 v93, v93
    v_mfma_f32_32x32x8_bf16 v[104:119], v[146:147], v[22:23], v[104:119]
    ds_read_b128 v[136:139], v164 offset:10240
    v_cvt_pk_bf16_f32 v121, v90, v91
    v_exp_f32 v94, v94
    v_exp_f32 v95, v95
    v_cvt_pk_bf16_f32 v122, v92, v93
    v_exp_f32 v96, v96
    v_exp_f32 v97, v97
    v_mfma_f32_32x32x16_bf16 v[72:87], v[148:151], v[128:131], v[72:87]
    s_mov_b64 exec, s[68:69]
    ds_read_b128 v[156:159], v165 offset:3840
    ds_read_b128 v[160:163], v165 offset:4480
    s_mov_b64 exec, -1
    v_cvt_pk_bf16_f32 v123, v94, v95
    v_exp_f32 v98, v98
    v_exp_f32 v99, v99
    v_cvt_pk_bf16_f32 v124, v96, v97
    v_exp_f32 v100, v100
    v_exp_f32 v101, v101
    v_mfma_f32_32x32x16_bf16 v[72:87], v[152:155], v[132:135], v[72:87]
    v_cvt_pk_bf16_f32 v125, v98, v99
    v_exp_f32 v102, v102
    v_exp_f32 v103, v103
    v_cvt_pk_bf16_f32 v126, v100, v101
    v_exp_f32 v104, v104
    v_cvt_pk_bf16_f32 v127, v102, v103
    s_waitcnt lgkmcnt(0)
    v_mfma_f32_32x32x16_bf16 v[88:103], v[136:139], v[8:11], v[24:39]
    v_exp_f32 v105, v105
    v_exp_f32 v106, v106
    v_exp_f32 v107, v107
    v_cvt_pk_bf16_f32 v128, v104, v105
    v_exp_f32 v108, v108
    v_exp_f32 v109, v109
    v_mfma_f32_32x32x8_bf16 v[88:103], v[144:145], v[16:17], v[88:103]
    v_add_u32 v164, 10240, v164
    v_add_u32 v165, 10240, v165
    v_add_u32 v196, 10240, v196
    v_cvt_pk_bf16_f32 v129, v106, v107
    v_exp_f32 v110, v110
    v_exp_f32 v111, v111
    v_cvt_pk_bf16_f32 v130, v108, v109
    v_exp_f32 v112, v112
    v_exp_f32 v113, v113
    v_mfma_f32_32x32x16_bf16 v[56:71], v[156:159], v[120:123], v[56:71]
    v_cvt_pk_bf16_f32 v131, v110, v111
    v_exp_f32 v114, v114
    v_exp_f32 v115, v115
    v_cvt_pk_bf16_f32 v132, v112, v113
    v_exp_f32 v116, v116
    v_exp_f32 v117, v117
    v_mfma_f32_32x32x16_bf16 v[56:71], v[160:163], v[124:127], v[56:71]
    v_cvt_pk_bf16_f32 v133, v114, v115
    v_exp_f32 v118, v118
    v_exp_f32 v119, v119
    v_cvt_pk_bf16_f32 v134, v116, v117
    s_add_u32 s35, s35, 1
    s_cmp_lt_u32 s35, 8
    s_cbranch_scc1 L_p2_loop
    s_cmp_eq_u32 s79, 1
    s_cbranch_scc1 L_p2_warm_ret
    v_cvt_pk_bf16_f32 v135, v118, v119
    v_mfma_f32_32x32x16_bf16 v[72:87], v[156:159], v[128:131], v[72:87]
    s_nop 0
    v_mfma_f32_32x32x16_bf16 v[72:87], v[160:163], v[132:135], v[72:87]
    s_mul_i32 s34, s22, 6144
    v_add_u32 v166, s34, v2
    s_cmp_ge_u32 s3, 4
    s_cbranch_scc1 L_p2_young
    v_mov_b32 v168, 2060
    v_mov_b32 v169, 1
    s_mov_b64 exec, 1
    ds_add_u32 v168, v169
    s_mov_b64 exec, -1
    s_mov_b32 s71, 0
    v_mov_b32 v186, 0
    v_mov_b32 v187, 0
    v_mov_b32 v188, 0
    v_mov_b32 v189, 0
    v_mov_b32 v190, 0
    s_cmp_ge_u32 s67, 28
    s_cbranch_scc1 L_p3w_side
    s_lshr_b32 s70, s66, 1
    s_mul_i32 s70, s70, 28
    s_add_u32 s70, s70, s67
    s_cmp_ge_u32 s70, 110
    s_cbranch_scc1 L_p3w_sdone
    s_mul_i32 s72, s70, 205
    s_lshr_b32 s72, s72, 10
    s_mul_i32 s72, s72, 5
    s_sub_u32 s70, s70, s72
    s_and_b32 s72, s66, 1
    s_mul_i32 s72, s72, 5
    s_add_u32 s70, s70, s72
    s_lshl_b32 s70, s70, 7
    s_mov_b32 s72, 1280
    s_mov_b32 s73, 10
    s_mov_b32 s71, 1
    s_branch L_p3w_pat
L_p3w_side:
    s_sub_u32 s70, s2, 224
    s_cmp_ge_u32 s70, 27
    s_cbranch_scc1 L_p3w_sdone
    s_lshl_b32 s70, s70, 7
    s_mov_b32 s72, 3456
    s_mov_b32 s73, 8
    s_mov_b32 s71, 2
    s_mov_b32 s8, s12
    s_mov_b32 s9, s13
    s_mov_b32 s10, s14
L_p3w_pat:
    v_lshrrev_b32 v191, 3, v1
    v_bfe_u32 v192, v1, 4, 1
    v_lshlrev_b32 v192, 2, v192
    v_and_b32 v193, 7, v1
    v_xor_b32 v193, v193, v192
    v_lshl_add_u32 v193, v193, 4, s70
    v_mov_b32 v195, s71
    v_cmp_eq_u32 vcc, 2, v195
    s_mul_i32 s73, s73, s72
    s_mul_i32 s70, s72, 80
    v_add_u32 v192, 0, v191
    v_mul_u32_u24 v194, 205, v192
    v_lshrrev_b32 v194, 11, v194
    v_mul_u32_u24 v194, 10, v194
    v_mov_b32 v195, 0
    v_cndmask_b32 v194, v194, v195, vcc
    v_add_u32 v192, v192, v194
    v_mad_u32_u24 v186, v192, s72, v193
    v_add_u32 v192, 8, v191
    v_mul_u32_u24 v194, 205, v192
    v_lshrrev_b32 v194, 11, v194
    v_mul_u32_u24 v194, 10, v194
    v_mov_b32 v195, 8
    v_cndmask_b32 v194, v194, v195, vcc
    v_add_u32 v192, v192, v194
    v_mad_u32_u24 v187, v192, s72, v193
    v_add_u32 v192, 16, v191
    v_mul_u32_u24 v194, 205, v192
    v_lshrrev_b32 v194, 11, v194
    v_mul_u32_u24 v194, 10, v194
    v_mov_b32 v195, 16
    v_cndmask_b32 v194, v194, v195, vcc
    v_add_u32 v192, v192, v194
    v_mad_u32_u24 v188, v192, s72, v193
    v_add_u32 v192, 24, v191
    v_mul_u32_u24 v194, 205, v192
    v_lshrrev_b32 v194, 11, v194
    v_mul_u32_u24 v194, 10, v194
    v_mov_b32 v195, 24
    v_cndmask_b32 v194, v194, v195, vcc
    v_add_u32 v192, v192, v194
    v_mad_u32_u24 v189, v192, s72, v193
    v_add_u32 v192, 32, v191
    v_mul_u32_u24 v194, 205, v192
    v_lshrrev_b32 v194, 11, v194
    v_mul_u32_u24 v194, 10, v194
    v_mov_b32 v195, 32
    v_cndmask_b32 v194, v194, v195, vcc
    v_add_u32 v192, v192, v194
    v_mad_u32_u24 v190, v192, s72, v193
L_p3w_sdone:
L_p2_spin:
    ds_read_b32 v169, v168
    s_waitcnt lgkmcnt(0)
    v_readfirstlane_b32 s28, v169
    s_cmp_ge_u32 s28, 4
    s_cbranch_scc1 L_p2_spun
    s_sleep 2
    s_branch L_p2_spin
L_p2_spun:
    ds_write_b128 v166, v[56:59] offset:0
    ds_write_b128 v166, v[60:63] offset:1024
    ds_write_b96 v166, v[64:66] offset:2048
    ds_write_b128 v166, v[72:75] offset:3072
    ds_write_b128 v166, v[76:79] offset:4096
    ds_write_b96 v166, v[80:82] offset:5120
    s_cmp_eq_u32 s71, 0
    s_cbranch_scc1 L_p3wa_skip
    s_add_u32 s28, s3, 0
    s_mul_i32 s29, s28, s70
    s_add_u32 s30, s29, s73
    s_mul_i32 s28, s28, 10240
    s_add_u32 s28, s28, 24576
    s_add_u32 m0, s28, 0
    s_nop 0
    buffer_load_dwordx4 v186, s[8:11], s29 offen lds
    s_add_u32 m0, s28, 1024
    s_nop 0
    buffer_load_dwordx4 v186, s[8:11], s30 offen lds
    s_add_u32 m0, s28, 2048
    s_nop 0
    buffer_load_dwordx4 v187, s[8:11], s29 offen lds
    s_add_u32 m0, s28, 3072
    s_nop 0
    buffer_load_dwordx4 v187, s[8:11], s30 offen lds
    s_add_u32 m0, s28, 4096
    s_nop 0
    buffer_load_dwordx4 v188, s[8:11], s29 offen lds
    s_add_u32 m0, s28, 5120
    s_nop 0
    buffer_load_dwordx4 v188, s[8:11], s30 offen lds
    s_add_u32 m0, s28, 6144
    s_nop 0
    buffer_load_dwordx4 v189, s[8:11], s29 offen lds
    s_add_u32 m0, s28, 7168
    s_nop 0
    buffer_load_dwordx4 v189, s[8:11], s30 offen lds
    s_add_u32 m0, s28, 8192
    s_nop 0
    buffer_load_dwordx4 v190, s[8:11], s29 offen lds
    s_add_u32 m0, s28, 9216
    s_nop 0
    buffer_load_dwordx4 v190, s[8:11], s30 offen lds
L_p3wa_skip:
    s_waitcnt lgkmcnt(0)
    s_barrier
    s_barrier
    s_cmp_eq_u32 s71, 0
    s_cbranch_scc1 L_p3wb_skip
    s_add_u32 s28, s3, 4
    s_mul_i32 s29, s28, s70
    s_add_u32 s30, s29, s73
    s_mul_i32 s28, s28, 10240
    s_add_u32 s28, s28, 24576
    s_add_u32 m0, s28, 0
    s_nop 0
    buffer_load_dwordx4 v186, s[8:11], s29 offen lds
    s_add_u32 m0, s28, 1024
    s_nop 0
    buffer_load_dwordx4 v186, s[8:11], s30 offen lds
    s_add_u32 m0, s28, 2048
    s_nop 0
    buffer_load_dwordx4 v187, s[8:11], s29 offen lds
    s_add_u32 m0, s28, 3072
    s_nop 0
    buffer_load_dwordx4 v187, s[8:11], s30 offen lds
    s_add_u32 m0, s28, 4096
    s_nop 0
    buffer_load_dwordx4 v188, s[8:11], s29 offen lds
    s_add_u32 m0, s28, 5120
    s_nop 0
    buffer_load_dwordx4 v188, s[8:11], s30 offen lds
    s_add_u32 m0, s28, 6144
    s_nop 0
    buffer_load_dwordx4 v189, s[8:11], s29 offen lds
    s_add_u32 m0, s28, 7168
    s_nop 0
    buffer_load_dwordx4 v189, s[8:11], s30 offen lds
    s_add_u32 m0, s28, 8192
    s_nop 0
    buffer_load_dwordx4 v190, s[8:11], s29 offen lds
    s_add_u32 m0, s28, 9216
    s_nop 0
    buffer_load_dwordx4 v190, s[8:11], s30 offen lds
L_p3wb_skip:
    s_branch L_p2_end
L_p2_young:
    s_mul_i32 s29, s20, 40
    s_lshr_b32 s30, s25, 2
    s_mul_i32 s30, s30, 5
    s_add_u32 s29, s29, s30
    s_lshl_b32 s29, s29, 10
    s_add_u32 s29, s29, 7340032
    s_lshl_b32 s31, s20, 2
    s_add_u32 s31, s31, s21
    s_add_u32 s31, s31, 384
    s_mov_b32 s33, 0x1f800000
    s_barrier
    ds_read_b128 v[88:91], v166 offset:0
    ds_read_b128 v[92:95], v166 offset:1024
    ds_read_b96 v[96:98], v166 offset:2048
    ds_read_b128 v[104:107], v166 offset:3072
    ds_read_b128 v[108:111], v166 offset:4096
    ds_read_b96 v[112:114], v166 offset:5120
    s_waitcnt lgkmcnt(3)
    v_add_f32 v66, v66, v98
    v_add_f32 v56, v56, v88
    v_add_f32 v57, v57, v89
    v_add_f32 v58, v58, v90
    v_add_f32 v59, v59, v91
    v_add_f32 v60, v60, v92
    v_add_f32 v61, v61, v93
    v_add_f32 v62, v62, v94
    v_add_f32 v63, v63, v95
    v_add_f32 v64, v64, v96
    v_add_f32 v65, v65, v97
    s_waitcnt lgkmcnt(0)
    v_add_f32 v82, v82, v114
    v_min_f32 v168, v66, v82
    v_add_f32 v169, v66, v82
    v_cmp_nle_f32 vcc, s33, v168
    v_cmp_u_f32 s[70:71], v169, v169
    v_add_f32 v72, v72, v104
    v_add_f32 v73, v73, v105
    v_add_f32 v74, v74, v106
    v_add_f32 v75, v75, v107
    v_add_f32 v76, v76, v108
    v_add_f32 v77, v77, v109
    v_add_f32 v78, v78, v110
    v_add_f32 v79, v79, v111
    v_add_f32 v80, v80, v112
    v_add_f32 v81, v81, v113
    s_or_b64 vcc, vcc, s[70:71]
    s_cbranch_vccnz L_p2_fallback
L_p2_final:
    v_rcp_f32 v168, v66
    v_rcp_f32 v169, v82
    s_and_b32 s30, s22, 1
    v_lshlrev_b32 v170, 3, v1
    v_mul_f32 v56, v56, v168
    v_mul_f32 v57, v57, v168
    v_mul_f32 v58, v58, v168
    v_mul_f32 v59, v59, v168
    v_mul_f32 v60, v60, v168
    v_mul_f32 v61, v61, v168
    v_mul_f32 v62, v62, v168
    v_mul_f32 v63, v63, v168
    v_mul_f32 v64, v64, v168
    v_mul_f32 v65, v65, v168
    v_mul_f32 v72, v72, v169
    v_mul_f32 v73, v73, v169
    v_mul_f32 v74, v74, v169
    v_mul_f32 v75, v75, v169
    v_mul_f32 v76, v76, v169
    v_mul_f32 v77, v77, v169
    v_mul_f32 v78, v78, v169
    v_mul_f32 v79, v79, v169
    v_mul_f32 v80, v80, v169
    v_mul_f32 v81, v81, v169
    v_cvt_pk_bf16_f32 v120, v56, v57
    v_cvt_pk_bf16_f32 v121, v58, v59
    v_cvt_pk_bf16_f32 v122, v60, v61
    v_cvt_pk_bf16_f32 v123, v62, v63
    v_cvt_pk_bf16_f32 v124, v64, v65
    v_cvt_pk_bf16_f32 v125, v72, v73
    v_cvt_pk_bf16_f32 v126, v74, v75
    v_cvt_pk_bf16_f32 v127, v76, v77
    v_cvt_pk_bf16_f32 v128, v78, v79
    v_cvt_pk_bf16_f32 v129, v80, v81
    s_cmp_eq_u32 s30, 1
    s_cbranch_scc1 L_p2_odd
    buffer_store_dwordx4 v[120:123], v2, s[4:7], s29 offen sc1
    buffer_store_dwordx4 v[124:127], v2, s[4:7], s29 offen offset:1024 sc1
    buffer_store_dwordx2 v[128:129], v170, s[4:7], s29 offen offset:2048 sc1
    s_branch L_p2_st1
L_p2_odd:
    s_add_u32 s30, s29, 4096
    buffer_store_dwordx2 v[120:121], v170, s[4:7], s29 offen offset:2560 sc1
    buffer_store_dwordx4 v[122:125], v2, s[4:7], s29 offen offset:3072 sc1
    buffer_store_dwordx4 v[126:129], v2, s[4:7], s30 offen sc1
L_p2_st1:
    s_barrier
    v_mov_b32 v166, 2076
    v_mov_b32 v167, 1
    s_mov_b64 exec, 1
    s_waitcnt vmcnt(0)
    ds_add_rtn_u32 v168, v166, v167
    s_waitcnt lgkmcnt(0)
    v_readfirstlane_b32 s74, v168
    s_cmp_lg_u32 s74, 3
    s_cbranch_scc1 L_p2_nosig
    s_mov_b64 exec, 0xff
    s_lshl_b32 s74, s31, 7
    s_add_u32 s74, s74, 262144
    v_mov_b32 v166, s76
    v_mov_b32 v167, s77
    v_mov_b32 v168, 0
    v_mov_b32 v169, 0
    buffer_store_dwordx4 v[166:169], v2, s[4:7], s74 offen sc1
L_p2_nosig:
    s_mov_b64 exec, -1
    s_cmp_lg_u32 s3, 7
    s_cbranch_scc1 L_p2_noep
    v_readfirstlane_b32 s28, v180
    s_and_b32 s28, s28, 255
    s_cmp_lg_u32 s28, 255
    s_cbranch_scc1 L_p2_noep
    v_mov_b32 v166, 0
    v_mov_b32 v168, s76
    v_mov_b32 v169, s77
    s_mov_b32 s28, 29184
    s_mov_b64 exec, 1
    buffer_store_dwordx2 v[168:169], v166, s[4:7], s28 offen sc1
    s_mov_b64 exec, -1
L_p2_noep:
L_p2_end:
    s_cmp_ge_u32 s67, 28
    s_cbranch_scc1 L_p3_side
    s_cmp_ge_u32 s67, 28
    s_cbranch_scc1 L_p3n_done
    s_lshr_b32 s22, s66, 1
    s_mul_i32 s22, s22, 28
    s_add_u32 s22, s22, s67
    s_cmp_ge_u32 s22, 110
    s_cbranch_scc1 L_p3n_done
    s_mul_i32 s21, s22, 205
    s_lshr_b32 s21, s21, 10
    s_mul_i32 s33, s21, 5
    s_sub_u32 s22, s22, s33
    s_and_b32 s20, s66, 1
    s_mul_i32 s20, s20, 5
    s_add_u32 s22, s22, s20
    s_mul_i32 s20, s21, 10
    s_add_u32 s20, s20, s22
    s_mul_i32 s33, s21, 3
    s_cmp_lt_u32 s3, 6
    s_cbranch_scc1 L_p3_compute
    s_mul_i32 s12, s33, 40960
    s_sub_u32 s14, 2621440, s12
    s_min_u32 s14, s14, 122880
    s_add_u32 s12, s12, 7340032
    s_add_u32 s12, s64, s12
    s_addc_u32 s13, s65, 0
    s_mov_b32 s15, 0x20000
    s_cmp_eq_u32 s3, 6
    s_cbranch_scc1 L_p3_t6
    v_mov_b32 v8, 163788
    v_mov_b32 v9, 0
    ds_write_b32 v8, v9
    s_waitcnt lgkmcnt(0)
    s_lshl_b32 s28, s33, 2
    v_add_u32 v8, s28, v1
    v_min_u32 v8, 255, v8
    v_add_u32 v8, 384, v8
    v_subrev_u32 v9, 10, v1
    v_min_u32 v9, 4, v9
    v_cmp_gt_u32 vcc, 12, v1
    v_lshlrev_b32 v13, 2, v1
    s_lshl_b32 s34, s22, 8
    v_cndmask_b32 v8, v9, v8, vcc
    s_waitcnt vmcnt(0) lgkmcnt(0)
    s_barrier
    v_lshlrev_b32 v8, 7, v8
    s_mov_b32 s74, 0
    s_mov_b32 s75, 262144
L_p3_poll:
    buffer_load_dwordx2 v[10:11], v8, s[4:7], s75 offen sc1
    s_add_u32 s74, s74, 1
    s_waitcnt vmcnt(0)
    v_cmp_ne_u64 vcc, s[76:77], v[10:11]
    s_cmp_gt_u32 s74, 400000
    s_cbranch_scc1 L_p3_go
    s_nop 2
    s_cbranch_vccz L_p3_go
    s_sleep 1
    s_branch L_p3_poll
L_p3_go:
    s_add_u32 s35, s34, 5120
    s_mov_b32 m0, 159744
    s_nop 0
    buffer_load_dword v13, s[4:7], s35 offen sc1 lds
    s_add_u32 s35, s34, 10240
    s_mov_b32 m0, 160000
    s_nop 0
    buffer_load_dword v13, s[4:7], s35 offen sc1 lds
    s_add_u32 s35, s34, 7680
    s_mov_b32 m0, 160256
    s_nop 0
    buffer_load_dword v13, s[4:7], s35 offen sc1 lds
    s_barrier
    s_mov_b32 s25, 0
    s_mov_b32 s26, 0
    s_mov_b32 s28, 0
    s_mov_b32 s24, 2
    s_mov_b32 s23, 0
L_p3b_ti:
    s_add_u32 m0, s26, 0
    s_add_u32 s27, s25, 0
    buffer_load_dwordx4 v2, s[12:15], s27 offen sc1 lds
    s_add_u32 m0, s26, 16384
    s_add_u32 s27, s25, 81920
    buffer_load_dwordx4 v2, s[12:15], s27 offen sc1 lds
    s_add_u32 m0, s26, 9216
    s_add_u32 s27, s25, 41984
    buffer_load_dwordx4 v2, s[12:15], s27 offen sc1 lds
    s_add_u32 m0, s26, 2048
    s_add_u32 s27, s25, 2048
    buffer_load_dwordx4 v2, s[12:15], s27 offen sc1 lds
    s_add_u32 m0, s26, 18432
    s_add_u32 s27, s25, 83968
    buffer_load_dwordx4 v2, s[12:15], s27 offen sc1 lds
    s_add_u32 m0, s26, 11264
    s_add_u32 s27, s25, 44032
    buffer_load_dwordx4 v2, s[12:15], s27 offen sc1 lds
    s_add_u32 m0, s26, 4096
    s_add_u32 s27, s25, 4096
    buffer_load_dwordx4 v2, s[12:15], s27 offen sc1 lds
    s_add_u32 m0, s26, 20480
    s_add_u32 s27, s25, 86016
    buffer_load_dwordx4 v2, s[12:15], s27 offen sc1 lds
    s_add_u32 m0, s26, 13312
    s_add_u32 s27, s25, 46080
    buffer_load_dwordx4 v2, s[12:15], s27 offen sc1 lds
    s_add_u32 m0, s26, 6144
    s_add_u32 s27, s25, 6144
    buffer_load_dwordx4 v2, s[12:15], s27 offen sc1 lds
    s_add_u32 m0, s26, 22528
    s_add_u32 s27, s25, 88064
    buffer_load_dwordx4 v2, s[12:15], s27 offen sc1 lds
    s_add_u32 m0, s26, 15360
    s_add_u32 s27, s25, 48128
    buffer_load_dwordx4 v2, s[12:15], s27 offen sc1 lds
    s_add_u32 s25, s25, 8192
    s_add_u32 s26, s26, 24576
    s_cmp_eq_u32 s26, 122880
    s_cselect_b32 s26, 0, s26
    s_add_u32 s28, s28, 1
    s_cmp_lt_u32 s28, s24
    s_cbranch_scc1 L_p3b_ti
    s_cmp_lg_u32 s23, 0
    s_cbranch_scc1 L_p3b_tr1
    s_waitcnt vmcnt(12)
    s_barrier
    s_mov_b32 s24, 4
    s_mov_b32 s23, 1
    s_branch L_p3b_ti
L_p3b_tr1:
    s_cmp_ge_u32 s28, 5
    s_cbranch_scc1 L_p3b_tt
    s_waitcnt vmcnt(24)
    s_barrier
    s_add_u32 s24, s24, 1
    s_branch L_p3b_ti
L_p3b_tt:
    s_waitcnt vmcnt(24)
    s_barrier
    s_waitcnt vmcnt(12)
    s_barrier
    s_waitcnt vmcnt(0)
    s_barrier
    s_barrier
    s_barrier
    s_branch L_p3_done
L_p3_t6:
    s_waitcnt vmcnt(0) lgkmcnt(0)
    s_barrier
    s_barrier
    s_mov_b32 s25, 0
    s_mov_b32 s26, 0
    s_mov_b32 s28, 0
    s_mov_b32 s24, 2
    s_mov_b32 s23, 0
L_p3a_ti:
    s_add_u32 m0, s26, 8192
    s_add_u32 s27, s25, 40960
    buffer_load_dwordx4 v2, s[12:15], s27 offen sc1 lds
    s_add_u32 m0, s26, 1024
    s_add_u32 s27, s25, 1024
    buffer_load_dwordx4 v2, s[12:15], s27 offen sc1 lds
    s_add_u32 m0, s26, 17408
    s_add_u32 s27, s25, 82944
    buffer_load_dwordx4 v2, s[12:15], s27 offen sc1 lds
    s_add_u32 m0, s26, 10240
    s_add_u32 s27, s25, 43008
    buffer_load_dwordx4 v2, s[12:15], s27 offen sc1 lds
    s_add_u32 m0, s26, 3072
    s_add_u32 s27, s25, 3072
    buffer_load_dwordx4 v2, s[12:15], s27 offen sc1 lds
    s_add_u32 m0, s26, 19456
    s_add_u32 s27, s25, 84992
    buffer_load_dwordx4 v2, s[12:15], s27 offen sc1 lds
    s_add_u32 m0, s26, 12288
    s_add_u32 s27, s25, 45056
    buffer_load_dwordx4 v2, s[12:15], s27 offen sc1 lds
    s_add_u32 m0, s26, 5120
    s_add_u32 s27, s25, 5120
    buffer_load_dwordx4 v2, s[12:15], s27 offen sc1 lds
    s_add_u32 m0, s26, 21504
    s_add_u32 s27, s25, 87040
    buffer_load_dwordx4 v2, s[12:15], s27 offen sc1 lds
    s_add_u32 m0, s26, 14336
    s_add_u32 s27, s25, 47104
    buffer_load_dwordx4 v2, s[12:15], s27 offen sc1 lds
    s_add_u32 m0, s26, 7168
    s_add_u32 s27, s25, 7168
    buffer_load_dwordx4 v2, s[12:15], s27 offen sc1 lds
    s_add_u32 m0, s26, 23552
    s_add_u32 s27, s25, 89088
    buffer_load_dwordx4 v2, s[12:15], s27 offen sc1 lds
    s_add_u32 s25, s25, 8192
    s_add_u32 s26, s26, 24576
    s_cmp_eq_u32 s26, 122880
    s_cselect_b32 s26, 0, s26
    s_add_u32 s28, s28, 1
    s_cmp_lt_u32 s28, s24
    s_cbranch_scc1 L_p3a_ti
    s_cmp_lg_u32 s23, 0
    s_cbranch_scc1 L_p3a_tr1
    s_waitcnt vmcnt(12)
    s_barrier
    s_mov_b32 s24, 4
    s_mov_b32 s23, 1
    s_branch L_p3a_ti
L_p3a_tr1:
    s_cmp_ge_u32 s28, 5
    s_cbranch_scc1 L_p3a_tt
    s_waitcnt vmcnt(24)
    s_barrier
    s_add_u32 s24, s24, 1
    s_branch L_p3a_ti
L_p3a_tt:
    s_waitcnt vmcnt(24)
    s_barrier
    s_waitcnt vmcnt(12)
    s_barrier
    s_waitcnt vmcnt(0)
    s_barrier
    s_barrier
    s_barrier
    s_branch L_p3_done
L_p3_side:
    s_sub_u32 s20, s2, 224
    s_cmp_gt_u32 s20, 27
    s_cbranch_scc1 L_p3_done
    v_min_u32 v12, 1, v1
    v_add_u32 v12, 3, v12
    s_cmp_eq_u32 s20, 27
    s_cbranch_scc1 L_p3_gram
    s_lshl_b32 s24, s20, 7
    s_mov_b32 s12, s50
    s_mov_b32 s13, s51
    s_mov_b32 s14, 3456
    s_mov_b32 s15, 0x20000
    v_lshlrev_b32 v9, 1, v1
    buffer_load_ushort v118, v9, s[12:15], s24 offen
    v_min_u32 v13, 2, v3
    v_mul_u32_u24 v13, 1280, v13
    v_lshl_add_u32 v13, v4, 4, v13
    v_add_u32 v13, 110592, v13
    v_lshlrev_b32 v9, 2, v0
    v_add_u32 v7, 110592, v9
    v_mov_b32 v10, 0x3f803f80
    ds_write_b32 v7, v10 offset:2560
    s_and_b32 s29, s3, 1
    s_lshr_b32 s30, s3, 1
    v_bfe_u32 v10, v1, 2, 2
    v_lshl_add_u32 v11, v4, 3, v10
    v_mul_u32_u24 v8, 128, v11
    v_lshrrev_b32 v10, 1, v10
    v_xor_b32 v10, s29, v10
    v_lshl_add_u32 v8, v10, 6, v8
    v_bfe_u32 v10, v1, 4, 1
    v_lshl_add_u32 v8, v10, 5, v8
    v_and_b32 v10, 1, v1
    v_lshl_add_u32 v8, v10, 4, v8
    v_bfe_u32 v10, v1, 1, 1
    v_lshl_add_u32 v8, v10, 3, v8
    s_mul_i32 s31, s30, 20480
    s_add_u32 s31, s31, 24576
    v_add_u32 v8, s31, v8
    s_mul_i32 s31, s30, 320
    v_add_u32 v13, s31, v13
    s_cmp_lg_u32 s3, 0
    s_cbranch_scc1 L_p3u_go
    v_lshlrev_b32 v12, 7, v12
    s_mov_b32 s74, 0
    s_mov_b32 s75, 262144
L_p3u_poll:
    buffer_load_dwordx2 v[14:15], v12, s[4:7], s75 offen sc1
    s_add_u32 s74, s74, 1
    s_waitcnt vmcnt(0)
    v_cmp_ne_u64 vcc, s[76:77], v[14:15]
    s_cmp_gt_u32 s74, 400000
    s_cbranch_scc1 L_p3u_go
    s_nop 2
    s_cbranch_vccz L_p3u_go
    s_sleep 1
    s_branch L_p3u_poll
L_p3u_go:
    s_waitcnt lgkmcnt(0)
    s_barrier
    s_mov_b32 s33, 24576
    buffer_load_dword v10, v9, s[4:7], s33 offen sc1
    buffer_load_dword v11, v9, s[4:7], s33 offen offset:2048 sc1
    s_waitcnt vmcnt(0)
    ds_write_b32 v7, v10
    v_cmp_gt_u32 vcc, 128, v0
    s_and_saveexec_b64 s[34:35], vcc
    ds_write_b32 v7, v11 offset:2048
    s_mov_b64 exec, s[34:35]
    s_waitcnt lgkmcnt(0)
    s_barrier
    ds_read_b128 v[16:19], v13 offset:0
    ds_read_b64_tr_b16 v[20:21], v8 offset:0
    ds_read_b64_tr_b16 v[22:23], v8 offset:512
    ds_read_b128 v[24:27], v13 offset:32
    ds_read_b64_tr_b16 v[28:29], v8 offset:2048
    ds_read_b64_tr_b16 v[30:31], v8 offset:2560
    ds_read_b128 v[32:35], v13 offset:64
    ds_read_b64_tr_b16 v[36:37], v8 offset:4096
    ds_read_b64_tr_b16 v[38:39], v8 offset:4608
    ds_read_b128 v[40:43], v13 offset:96
    ds_read_b64_tr_b16 v[44:45], v8 offset:6144
    ds_read_b64_tr_b16 v[46:47], v8 offset:6656
    ds_read_b128 v[48:51], v13 offset:128
    ds_read_b64_tr_b16 v[52:53], v8 offset:8192
    ds_read_b64_tr_b16 v[54:55], v8 offset:8704
    s_waitcnt lgkmcnt(0)
    v_mfma_f32_32x32x16_bf16 v[100:115], v[20:23], v[16:19], 0
    v_mfma_f32_32x32x16_bf16 v[100:115], v[28:31], v[24:27], v[100:115]
    v_mfma_f32_32x32x16_bf16 v[100:115], v[36:39], v[32:35], v[100:115]
    v_mfma_f32_32x32x16_bf16 v[100:115], v[44:47], v[40:43], v[100:115]
    v_mfma_f32_32x32x16_bf16 v[100:115], v[52:55], v[48:51], v[100:115]
    ds_read_b128 v[56:59], v13 offset:160
    ds_read_b64_tr_b16 v[60:61], v8 offset:10240
    ds_read_b64_tr_b16 v[62:63], v8 offset:10752
    ds_read_b128 v[64:67], v13 offset:192
    ds_read_b64_tr_b16 v[68:69], v8 offset:12288
    ds_read_b64_tr_b16 v[70:71], v8 offset:12800
    ds_read_b128 v[72:75], v13 offset:224
    ds_read_b64_tr_b16 v[76:77], v8 offset:14336
    ds_read_b64_tr_b16 v[78:79], v8 offset:14848
    ds_read_b128 v[80:83], v13 offset:256
    ds_read_b64_tr_b16 v[84:85], v8 offset:16384
    ds_read_b64_tr_b16 v[86:87], v8 offset:16896
    ds_read_b128 v[88:91], v13 offset:288
    ds_read_b64_tr_b16 v[92:93], v8 offset:18432
    ds_read_b64_tr_b16 v[94:95], v8 offset:18944
    s_waitcnt lgkmcnt(0)
    v_mfma_f32_32x32x16_bf16 v[100:115], v[60:63], v[56:59], v[100:115]
    v_mfma_f32_32x32x16_bf16 v[100:115], v[68:71], v[64:67], v[100:115]
    v_mfma_f32_32x32x16_bf16 v[100:115], v[76:79], v[72:75], v[100:115]
    v_mfma_f32_32x32x16_bf16 v[100:115], v[84:87], v[80:83], v[100:115]
    v_mfma_f32_32x32x16_bf16 v[100:115], v[92:95], v[88:91], v[100:115]
    s_lshl_b32 s31, s30, 10
    s_lshl_b32 s34, s29, 7
    s_add_u32 s31, s31, s34
    s_add_u32 s31, s31, 114688
    v_lshlrev_b32 v10, 8, v3
    v_lshl_add_u32 v10, v4, 5, v10
    v_add_u32 v10, s31, v10
    v_lshlrev_b32 v11, 2, v1
    v_add_u32 v11, 114688, v11
    s_nop 2
    s_mov_b32 exec_lo, 7
    s_mov_b32 exec_hi, 7
    ds_write_b128 v10, v[100:103]
    ds_write_b128 v10, v[104:107] offset:16
    ds_write_b128 v10, v[108:111] offset:64
    ds_write_b128 v10, v[112:115] offset:80
    s_mov_b64 exec, -1
    s_waitcnt lgkmcnt(0)
    s_barrier
    s_cmp_lg_u32 s3, 0
    s_cbranch_scc1 L_p3_done
    ds_read_b32 v20, v11 offset:0
    ds_read_b32 v21, v11 offset:1024
    ds_read_b32 v22, v11 offset:2048
    ds_read_b32 v23, v11 offset:3072
    ds_read_b32 v24, v11 offset:256
    ds_read_b32 v25, v11 offset:1280
    ds_read_b32 v26, v11 offset:2304
    ds_read_b32 v27, v11 offset:3328
    ds_read_b32 v28, v11 offset:512
    ds_read_b32 v29, v11 offset:1536
    ds_read_b32 v30, v11 offset:2560
    ds_read_b32 v31, v11 offset:3584
    s_mov_b32 s34, 0xffff0000
    s_mov_b32 s35, 0xffff
    s_waitcnt lgkmcnt(0)
    v_add_f32 v20, v20, v21
    v_add_f32 v22, v22, v23
    v_add_f32 v61, v20, v22
    v_cvt_pk_bf16_f32 v64, v61, v61
    v_and_b32 v70, s34, v64
    v_sub_f32 v70, v61, v70
    v_cvt_pk_bf16_f32 v67, v70, v70
    v_add_f32 v24, v24, v25
    v_add_f32 v26, v26, v27
    v_add_f32 v62, v24, v26
    v_cvt_pk_bf16_f32 v65, v62, v62
    v_and_b32 v70, s34, v65
    v_sub_f32 v70, v62, v70
    v_cvt_pk_bf16_f32 v68, v70, v70
    v_add_f32 v28, v28, v29
    v_add_f32 v30, v30, v31
    v_add_f32 v63, v28, v30
    v_cvt_pk_bf16_f32 v66, v63, v63
    v_and_b32 v70, s34, v66
    v_sub_f32 v70, v63, v70
    v_cvt_pk_bf16_f32 v69, v70, v70
    v_mov_b32 v72, v64
    v_bfi_b32 v73, s35, v67, v65
    v_bfi_b32 v74, s35, v65, v68
    v_mov_b32 v75, v66
    v_and_b32 v76, s35, v69
    v_lshl_or_b32 v76, v118, 16, v76
    v_mov_b32 v77, v118
    v_mov_b32 v78, 0
    v_mov_b32 v79, 0
    v_lshlrev_b32 v10, 10, v4
    v_and_b32 v11, 19, v1
    v_bfe_u32 v12, v1, 2, 1
    v_lshl_add_u32 v11, v12, 3, v11
    v_bfe_u32 v12, v1, 3, 1
    v_lshl_add_u32 v11, v12, 2, v11
    v_lshl_add_u32 v10, v11, 4, v10
    s_lshl_b32 s33, s20, 11
    s_add_u32 s33, s33, 196608
    buffer_store_dwordx4 v[72:75], v10, s[4:7], s33 offen sc1
    buffer_store_dwordx4 v[76:79], v10, s[4:7], s33 offen offset:512 sc1
    s_add_u32 s34, s20, 1152
    s_waitcnt vmcnt(0)
    s_mov_b64 exec, 1
    s_mov_b64 exec, 0xff
    s_lshl_b32 s74, s34, 7
    s_add_u32 s74, s74, 262144
    v_mov_b32 v14, s76
    v_mov_b32 v15, s77
    v_mov_b32 v16, 0
    v_mov_b32 v17, 0
    buffer_store_dwordx4 v[14:17], v2, s[4:7], s74 offen sc1
    s_mov_b64 exec, -1
    s_branch L_p3_done
L_p3_gram:
    s_cmp_lg_u32 s3, 0
    s_cbranch_scc1 L_p3_done
    v_lshlrev_b32 v12, 7, v12
    s_mov_b32 s74, 0
    s_mov_b32 s75, 262144
L_p3g_poll:
    buffer_load_dwordx2 v[14:15], v12, s[4:7], s75 offen sc1
    s_add_u32 s74, s74, 1
    s_waitcnt vmcnt(0)
    v_cmp_ne_u64 vcc, s[76:77], v[14:15]
    s_cmp_gt_u32 s74, 400000
    s_cbranch_scc1 L_p3g_go
    s_nop 2
    s_cbranch_vccz L_p3g_go
    s_sleep 1
    s_branch L_p3g_poll
L_p3g_go:
    v_lshlrev_b32 v9, 2, v1
    s_mov_b32 s34, 7680
    s_mov_b32 s35, 10240
    buffer_load_dword v10, v9, s[4:7], s34 offen offset:0 sc1
    buffer_load_dword v20, v9, s[4:7], s35 offen offset:0 sc1
    buffer_load_dword v11, v9, s[4:7], s34 offen offset:256 sc1
    buffer_load_dword v21, v9, s[4:7], s35 offen offset:256 sc1
    buffer_load_dword v12, v9, s[4:7], s34 offen offset:512 sc1
    buffer_load_dword v22, v9, s[4:7], s35 offen offset:512 sc1
    buffer_load_dword v13, v9, s[4:7], s34 offen offset:768 sc1
    buffer_load_dword v23, v9, s[4:7], s35 offen offset:768 sc1
    buffer_load_dword v14, v9, s[4:7], s34 offen offset:1024 sc1
    buffer_load_dword v24, v9, s[4:7], s35 offen offset:1024 sc1
    buffer_load_dword v15, v9, s[4:7], s34 offen offset:1280 sc1
    buffer_load_dword v25, v9, s[4:7], s35 offen offset:1280 sc1
    buffer_load_dword v16, v9, s[4:7], s34 offen offset:1536 sc1
    buffer_load_dword v26, v9, s[4:7], s35 offen offset:1536 sc1
    buffer_load_dword v17, v9, s[4:7], s34 offen offset:1792 sc1
    buffer_load_dword v27, v9, s[4:7], s35 offen offset:1792 sc1
    buffer_load_dword v18, v9, s[4:7], s34 offen offset:2048 sc1
    buffer_load_dword v28, v9, s[4:7], s35 offen offset:2048 sc1
    buffer_load_dword v19, v9, s[4:7], s34 offen offset:2304 sc1
    buffer_load_dword v29, v9, s[4:7], s35 offen offset:2304 sc1
    s_waitcnt vmcnt(0)
    v_mov_b32 v30, v20
    v_mul_f32 v31, v20, v20
    v_mov_b32 v32, v10
    v_mul_f32 v33, v10, v10
    v_mul_f32 v34, v10, v20
    v_add_f32 v30, v30, v21
    v_fmac_f32 v31, v21, v21
    v_add_f32 v32, v32, v11
    v_fmac_f32 v33, v11, v11
    v_fmac_f32 v34, v11, v21
    v_add_f32 v30, v30, v22
    v_fmac_f32 v31, v22, v22
    v_add_f32 v32, v32, v12
    v_fmac_f32 v33, v12, v12
    v_fmac_f32 v34, v12, v22
    v_add_f32 v30, v30, v23
    v_fmac_f32 v31, v23, v23
    v_add_f32 v32, v32, v13
    v_fmac_f32 v33, v13, v13
    v_fmac_f32 v34, v13, v23
    v_add_f32 v30, v30, v24
    v_fmac_f32 v31, v24, v24
    v_add_f32 v32, v32, v14
    v_fmac_f32 v33, v14, v14
    v_fmac_f32 v34, v14, v24
    v_add_f32 v30, v30, v25
    v_fmac_f32 v31, v25, v25
    v_add_f32 v32, v32, v15
    v_fmac_f32 v33, v15, v15
    v_fmac_f32 v34, v15, v25
    v_add_f32 v30, v30, v26
    v_fmac_f32 v31, v26, v26
    v_add_f32 v32, v32, v16
    v_fmac_f32 v33, v16, v16
    v_fmac_f32 v34, v16, v26
    v_add_f32 v30, v30, v27
    v_fmac_f32 v31, v27, v27
    v_add_f32 v32, v32, v17
    v_fmac_f32 v33, v17, v17
    v_fmac_f32 v34, v17, v27
    v_add_f32 v30, v30, v28
    v_fmac_f32 v31, v28, v28
    v_add_f32 v32, v32, v18
    v_fmac_f32 v33, v18, v18
    v_fmac_f32 v34, v18, v28
    v_add_f32 v30, v30, v29
    v_fmac_f32 v31, v29, v29
    v_add_f32 v32, v32, v19
    v_fmac_f32 v33, v19, v19
    v_fmac_f32 v34, v19, v29
    v_add_f32_dpp v30, v30, v30 quad_perm:[1,0,3,2] row_mask:0xf bank_mask:0xf
    v_add_f32_dpp v31, v31, v31 quad_perm:[1,0,3,2] row_mask:0xf bank_mask:0xf
    v_add_f32_dpp v32, v32, v32 quad_perm:[1,0,3,2] row_mask:0xf bank_mask:0xf
    v_add_f32_dpp v33, v33, v33 quad_perm:[1,0,3,2] row_mask:0xf bank_mask:0xf
    v_add_f32_dpp v34, v34, v34 quad_perm:[1,0,3,2] row_mask:0xf bank_mask:0xf
    v_add_f32_dpp v30, v30, v30 quad_perm:[2,3,0,1] row_mask:0xf bank_mask:0xf
    v_add_f32_dpp v31, v31, v31 quad_perm:[2,3,0,1] row_mask:0xf bank_mask:0xf
    v_add_f32_dpp v32, v32, v32 quad_perm:[2,3,0,1] row_mask:0xf bank_mask:0xf
    v_add_f32_dpp v33, v33, v33 quad_perm:[2,3,0,1] row_mask:0xf bank_mask:0xf
    v_add_f32_dpp v34, v34, v34 quad_perm:[2,3,0,1] row_mask:0xf bank_mask:0xf
    v_add_f32_dpp v30, v30, v30 row_half_mirror row_mask:0xf bank_mask:0xf
    v_add_f32_dpp v31, v31, v31 row_half_mirror row_mask:0xf bank_mask:0xf
    v_add_f32_dpp v32, v32, v32 row_half_mirror row_mask:0xf bank_mask:0xf
    v_add_f32_dpp v33, v33, v33 row_half_mirror row_mask:0xf bank_mask:0xf
    v_add_f32_dpp v34, v34, v34 row_half_mirror row_mask:0xf bank_mask:0xf
    v_add_f32_dpp v30, v30, v30 row_mirror row_mask:0xf bank_mask:0xf
    v_add_f32_dpp v31, v31, v31 row_mirror row_mask:0xf bank_mask:0xf
    v_add_f32_dpp v32, v32, v32 row_mirror row_mask:0xf bank_mask:0xf
    v_add_f32_dpp v33, v33, v33 row_mirror row_mask:0xf bank_mask:0xf
    v_add_f32_dpp v34, v34, v34 row_mirror row_mask:0xf bank_mask:0xf
    v_mov_b32 v36, v30
    s_nop 1
    v_permlane32_swap_b32 v30, v36
    v_add_f32 v30, v30, v36
    v_mov_b32 v36, v31
    s_nop 1
    v_permlane32_swap_b32 v31, v36
    v_add_f32 v31, v31, v36
    v_mov_b32 v36, v32
    s_nop 1
    v_permlane32_swap_b32 v32, v36
    v_add_f32 v32, v32, v36
    v_mov_b32 v36, v33
    s_nop 1
    v_permlane32_swap_b32 v33, v36
    v_add_f32 v33, v33, v36
    v_mov_b32 v36, v34
    s_nop 1
    v_permlane32_swap_b32 v34, v36
    v_add_f32 v34, v34, v36
    s_nop 0
    v_readlane_b32 s34, v30, 16
    s_nop 1
    v_add_f32 v30, s34, v30
    v_mul_f32 v30, 0x3acccccd, v30
    s_nop 0
    v_readlane_b32 s34, v31, 16
    s_nop 1
    v_add_f32 v31, s34, v31
    v_mul_f32 v31, 0x3acccccd, v31
    s_nop 0
    v_readlane_b32 s34, v32, 16
    s_nop 1
    v_add_f32 v32, s34, v32
    v_mul_f32 v32, 0x3acccccd, v32
    s_nop 0
    v_readlane_b32 s34, v33, 16
    s_nop 1
    v_add_f32 v33, s34, v33
    v_mul_f32 v33, 0x3acccccd, v33
    s_nop 0
    v_readlane_b32 s34, v34, 16
    s_nop 1
    v_add_f32 v34, s34, v34
    v_mul_f32 v34, 0x3acccccd, v34
    v_mov_b32 v5, 0
    s_mov_b32 s34, 28672
    s_mov_b64 exec, 1
    buffer_store_dwordx2 v[30:31], v5, s[4:7], s34 offen sc1
    buffer_store_dwordx2 v[32:33], v5, s[4:7], s34 offen offset:8 sc1
    buffer_store_dword v34, v5, s[4:7], s34 offen offset:16 sc1
    s_waitcnt vmcnt(0)
    s_mov_b32 s34, 1179
    s_mov_b64 exec, 0xff
    s_lshl_b32 s74, s34, 7
    s_add_u32 s74, s74, 262144
    v_mov_b32 v14, s76
    v_mov_b32 v15, s77
    v_mov_b32 v16, 0
    v_mov_b32 v17, 0
    buffer_store_dwordx4 v[14:17], v2, s[4:7], s74 offen sc1
    s_mov_b64 exec, -1
    s_branch L_p3_done
L_p3_compute:
    s_cmp_ge_u32 s3, 3
    s_cselect_b32 s35, 1, 0
    s_mul_i32 s34, s35, 3
    s_sub_u32 s34, s3, s34
    s_add_u32 s23, s33, s34
    s_lshl_b32 s69, s22, 1
    s_add_u32 s69, s69, s35
    s_mov_b32 s16, s36
    s_mov_b32 s17, s37
    s_mov_b32 s18, 2621440
    s_mov_b32 s19, 0x20000
    v_mul_u32_u24 v14, 1280, v3
    v_lshl_add_u32 v14, v4, 4, v14
    s_mul_i32 s24, s23, 40960
    s_lshl_b32 s25, s69, 6
    s_add_u32 s24, s24, s25
    s_min_u32 s24, s24, 2621440
    buffer_load_dwordx4 v[64:67], v14, s[16:19], s24 offen
    buffer_load_dwordx4 v[68:71], v14, s[16:19], s24 offen offset:32
    s_add_u32 s68, s20, 640
    v_bfe_u32 v10, v1, 2, 2
    v_lshl_add_u32 v11, v4, 3, v10
    v_mul_u32_u24 v8, 128, v11
    v_lshrrev_b32 v10, 1, v10
    v_xor_b32 v10, s35, v10
    v_lshl_add_u32 v8, v10, 6, v8
    v_bfe_u32 v10, v1, 4, 1
    v_lshl_add_u32 v8, v10, 5, v8
    v_and_b32 v10, 1, v1
    v_lshl_add_u32 v8, v10, 4, v8
    v_bfe_u32 v10, v1, 1, 1
    v_lshl_add_u32 v8, v10, 3, v8
    v_add_u32 v8, 24576, v8
    v_add_u32 v9, 40960, v8
    s_lshl_b32 s30, s34, 13
    v_add_u32 v10, s30, v2
    v_add_u32 v11, 49152, v10
    v_add_u32 v12, 98304, v10
    v_lshl_add_u32 v13, v1, 3, s30
    v_add_u32 v14, 49152, v13
    v_add_u32 v15, 98304, v13
    s_waitcnt vmcnt(0) lgkmcnt(0)
    s_barrier
    ds_read_b64_tr_b16 v[96:97], v8 offset:0
    ds_read_b64_tr_b16 v[98:99], v8 offset:512
    ds_read_b64_tr_b16 v[100:101], v8 offset:2048
    ds_read_b64_tr_b16 v[102:103], v8 offset:2560
    ds_read_b64_tr_b16 v[104:105], v8 offset:4096
    ds_read_b64_tr_b16 v[106:107], v8 offset:4608
    ds_read_b64_tr_b16 v[108:109], v8 offset:6144
    ds_read_b64_tr_b16 v[110:111], v8 offset:6656
    ds_read_b64_tr_b16 v[112:113], v8 offset:8192
    ds_read_b64_tr_b16 v[114:115], v8 offset:8704
    ds_read_b64_tr_b16 v[116:117], v8 offset:10240
    ds_read_b64_tr_b16 v[118:119], v8 offset:10752
    ds_read_b64_tr_b16 v[120:121], v8 offset:12288
    ds_read_b64_tr_b16 v[122:123], v8 offset:12800
    ds_read_b64_tr_b16 v[124:125], v8 offset:14336
    ds_read_b64_tr_b16 v[126:127], v8 offset:14848
    ds_read_b64_tr_b16 v[128:129], v8 offset:16384
    ds_read_b64_tr_b16 v[130:131], v8 offset:16896
    ds_read_b64_tr_b16 v[132:133], v8 offset:18432
    ds_read_b64_tr_b16 v[134:135], v8 offset:18944
    ds_read_b64_tr_b16 v[136:137], v8 offset:20480
    ds_read_b64_tr_b16 v[138:139], v8 offset:20992
    ds_read_b64_tr_b16 v[140:141], v8 offset:22528
    ds_read_b64_tr_b16 v[142:143], v8 offset:23040
    ds_read_b64_tr_b16 v[144:145], v8 offset:24576
    ds_read_b64_tr_b16 v[146:147], v8 offset:25088
    ds_read_b64_tr_b16 v[148:149], v8 offset:26624
    ds_read_b64_tr_b16 v[150:151], v8 offset:27136
    ds_read_b64_tr_b16 v[152:153], v8 offset:28672
    ds_read_b64_tr_b16 v[154:155], v8 offset:29184
    ds_read_b64_tr_b16 v[156:157], v8 offset:30720
    ds_read_b64_tr_b16 v[158:159], v8 offset:31232
    ds_read_b64_tr_b16 v[160:161], v8 offset:32768
    ds_read_b64_tr_b16 v[162:163], v8 offset:33280
    ds_read_b64_tr_b16 v[164:165], v8 offset:34816
    ds_read_b64_tr_b16 v[166:167], v8 offset:35328
    ds_read_b64_tr_b16 v[168:169], v8 offset:36864
    ds_read_b64_tr_b16 v[170:171], v8 offset:37376
    ds_read_b64_tr_b16 v[172:173], v8 offset:38912
    ds_read_b64_tr_b16 v[174:175], v8 offset:39424
    ds_read_b64_tr_b16 v[176:177], v9 offset:0
    ds_read_b64_tr_b16 v[178:179], v9 offset:512
    ds_read_b64_tr_b16 v[180:181], v9 offset:2048
    ds_read_b64_tr_b16 v[182:183], v9 offset:2560
    ds_read_b64_tr_b16 v[184:185], v9 offset:4096
    ds_read_b64_tr_b16 v[186:187], v9 offset:4608
    ds_read_b64_tr_b16 v[188:189], v9 offset:6144
    ds_read_b64_tr_b16 v[190:191], v9 offset:6656
    ds_read_b64_tr_b16 v[192:193], v9 offset:8192
    ds_read_b64_tr_b16 v[194:195], v9 offset:8704
    ds_read_b64_tr_b16 v[196:197], v9 offset:10240
    ds_read_b64_tr_b16 v[198:199], v9 offset:10752
    ds_read_b64_tr_b16 v[200:201], v9 offset:12288
    ds_read_b64_tr_b16 v[202:203], v9 offset:12800
    ds_read_b64_tr_b16 v[204:205], v9 offset:14336
    ds_read_b64_tr_b16 v[206:207], v9 offset:14848
    ds_read_b64_tr_b16 v[208:209], v9 offset:16384
    ds_read_b64_tr_b16 v[210:211], v9 offset:16896
    ds_read_b64_tr_b16 v[212:213], v9 offset:18432
    ds_read_b64_tr_b16 v[214:215], v9 offset:18944
    ds_read_b64_tr_b16 v[216:217], v9 offset:20480
    ds_read_b64_tr_b16 v[218:219], v9 offset:20992
    ds_read_b64_tr_b16 v[220:221], v9 offset:22528
    ds_read_b64_tr_b16 v[222:223], v9 offset:23040
    ds_read_b64_tr_b16 v[224:225], v9 offset:24576
    ds_read_b64_tr_b16 v[226:227], v9 offset:25088
    ds_read_b64_tr_b16 v[228:229], v9 offset:26624
    ds_read_b64_tr_b16 v[230:231], v9 offset:27136
    ds_read_b64_tr_b16 v[232:233], v9 offset:28672
    ds_read_b64_tr_b16 v[234:235], v9 offset:29184
    ds_read_b64_tr_b16 v[236:237], v9 offset:30720
    ds_read_b64_tr_b16 v[238:239], v9 offset:31232
    ds_read_b64_tr_b16 v[240:241], v9 offset:32768
    ds_read_b64_tr_b16 v[242:243], v9 offset:33280
    ds_read_b64_tr_b16 v[244:245], v9 offset:34816
    ds_read_b64_tr_b16 v[246:247], v9 offset:35328
    ds_read_b64_tr_b16 v[248:249], v9 offset:36864
    ds_read_b64_tr_b16 v[250:251], v9 offset:37376
    ds_read_b64_tr_b16 v[252:253], v9 offset:38912
    ds_read_b64_tr_b16 v[254:255], v9 offset:39424
    s_waitcnt lgkmcnt(0)
    s_barrier
    s_barrier
    ds_read_b128 v[32:35], v10 offset:0
    ds_read_b128 v[36:39], v10 offset:1024
    ds_read_b64 v[40:41], v13 offset:2048
    ds_read_b64 v[42:43], v13 offset:2560
    ds_read_b128 v[44:47], v10 offset:3072
    ds_read_b128 v[48:51], v10 offset:4096
    ds_read_b128 v[52:55], v10 offset:5120
    ds_read_b128 v[56:59], v10 offset:6144
    ds_read_b64 v[60:61], v13 offset:7168
    ds_read_b64 v[62:63], v13 offset:7680
    s_waitcnt lgkmcnt(9)
    v_mfma_f32_32x32x16_bf16 v[16:31], v[96:99], v[32:35], 0
    s_waitcnt lgkmcnt(8)
    v_mfma_f32_32x32x16_bf16 v[16:31], v[100:103], v[36:39], v[16:31]
    s_waitcnt lgkmcnt(6)
    v_mfma_f32_32x32x16_bf16 v[16:31], v[104:107], v[40:43], v[16:31]
    s_waitcnt lgkmcnt(5)
    v_mfma_f32_32x32x16_bf16 v[16:31], v[108:111], v[44:47], v[16:31]
    s_waitcnt lgkmcnt(4)
    v_mfma_f32_32x32x16_bf16 v[16:31], v[112:115], v[48:51], v[16:31]
    s_waitcnt lgkmcnt(3)
    v_mfma_f32_32x32x16_bf16 v[16:31], v[116:119], v[52:55], v[16:31]
    s_waitcnt lgkmcnt(2)
    v_mfma_f32_32x32x16_bf16 v[16:31], v[120:123], v[56:59], v[16:31]
    s_waitcnt lgkmcnt(0)
    v_mfma_f32_32x32x16_bf16 v[16:31], v[124:127], v[60:63], v[16:31]
    s_barrier
    ds_read_b128 v[32:35], v10 offset:24576
    ds_read_b128 v[36:39], v10 offset:25600
    ds_read_b128 v[40:43], v10 offset:26624
    ds_read_b128 v[44:47], v10 offset:27648
    ds_read_b64 v[48:49], v13 offset:28672
    ds_read_b64 v[50:51], v13 offset:29184
    ds_read_b128 v[52:55], v10 offset:29696
    ds_read_b128 v[56:59], v10 offset:30720
    ds_read_b128 v[60:63], v10 offset:31744
    s_waitcnt lgkmcnt(8)
    v_mfma_f32_32x32x16_bf16 v[16:31], v[128:131], v[32:35], v[16:31]
    s_waitcnt lgkmcnt(7)
    v_mfma_f32_32x32x16_bf16 v[16:31], v[132:135], v[36:39], v[16:31]
    s_waitcnt lgkmcnt(6)
    v_mfma_f32_32x32x16_bf16 v[16:31], v[136:139], v[40:43], v[16:31]
    s_waitcnt lgkmcnt(5)
    v_mfma_f32_32x32x16_bf16 v[16:31], v[140:143], v[44:47], v[16:31]
    s_waitcnt lgkmcnt(3)
    v_mfma_f32_32x32x16_bf16 v[16:31], v[144:147], v[48:51], v[16:31]
    s_waitcnt lgkmcnt(2)
    v_mfma_f32_32x32x16_bf16 v[16:31], v[148:151], v[52:55], v[16:31]
    s_waitcnt lgkmcnt(1)
    v_mfma_f32_32x32x16_bf16 v[16:31], v[152:155], v[56:59], v[16:31]
    s_waitcnt lgkmcnt(0)
    v_mfma_f32_32x32x16_bf16 v[16:31], v[156:159], v[60:63], v[16:31]
    s_barrier
    ds_read_b128 v[32:35], v11 offset:0
    ds_read_b64 v[36:37], v14 offset:1024
    ds_read_b64 v[38:39], v14 offset:1536
    ds_read_b128 v[40:43], v11 offset:2048
    ds_read_b128 v[44:47], v11 offset:3072
    ds_read_b128 v[48:51], v11 offset:4096
    ds_read_b128 v[52:55], v11 offset:5120
    ds_read_b64 v[56:57], v14 offset:6144
    ds_read_b64 v[58:59], v14 offset:6656
    ds_read_b128 v[60:63], v11 offset:7168
    s_waitcnt lgkmcnt(9)
    v_mfma_f32_32x32x16_bf16 v[16:31], v[160:163], v[32:35], v[16:31]
    s_waitcnt lgkmcnt(7)
    v_mfma_f32_32x32x16_bf16 v[16:31], v[164:167], v[36:39], v[16:31]
    s_waitcnt lgkmcnt(6)
    v_mfma_f32_32x32x16_bf16 v[16:31], v[168:171], v[40:43], v[16:31]
    s_waitcnt lgkmcnt(5)
    v_mfma_f32_32x32x16_bf16 v[16:31], v[172:175], v[44:47], v[16:31]
    s_waitcnt lgkmcnt(4)
    v_mfma_f32_32x32x16_bf16 v[16:31], v[176:179], v[48:51], v[16:31]
    s_waitcnt lgkmcnt(3)
    v_mfma_f32_32x32x16_bf16 v[16:31], v[180:183], v[52:55], v[16:31]
    s_waitcnt lgkmcnt(1)
    v_mfma_f32_32x32x16_bf16 v[16:31], v[184:187], v[56:59], v[16:31]
    s_waitcnt lgkmcnt(0)
    v_mfma_f32_32x32x16_bf16 v[16:31], v[188:191], v[60:63], v[16:31]
    s_barrier
    ds_read_b128 v[32:35], v11 offset:24576
    ds_read_b128 v[36:39], v11 offset:25600
    ds_read_b128 v[40:43], v11 offset:26624
    ds_read_b64 v[44:45], v14 offset:27648
    ds_read_b64 v[46:47], v14 offset:28160
    ds_read_b128 v[48:51], v11 offset:28672
    ds_read_b128 v[52:55], v11 offset:29696
    ds_read_b128 v[56:59], v11 offset:30720
    ds_read_b128 v[60:63], v11 offset:31744
    s_waitcnt lgkmcnt(8)
    v_mfma_f32_32x32x16_bf16 v[16:31], v[192:195], v[32:35], v[16:31]
    s_waitcnt lgkmcnt(7)
    v_mfma_f32_32x32x16_bf16 v[16:31], v[196:199], v[36:39], v[16:31]
    s_waitcnt lgkmcnt(6)
    v_mfma_f32_32x32x16_bf16 v[16:31], v[200:203], v[40:43], v[16:31]
    s_waitcnt lgkmcnt(4)
    v_mfma_f32_32x32x16_bf16 v[16:31], v[204:207], v[44:47], v[16:31]
    s_waitcnt lgkmcnt(3)
    v_mfma_f32_32x32x16_bf16 v[16:31], v[208:211], v[48:51], v[16:31]
    s_waitcnt lgkmcnt(2)
    v_mfma_f32_32x32x16_bf16 v[16:31], v[212:215], v[52:55], v[16:31]
    s_waitcnt lgkmcnt(1)
    v_mfma_f32_32x32x16_bf16 v[16:31], v[216:219], v[56:59], v[16:31]
    s_waitcnt lgkmcnt(0)
    v_mfma_f32_32x32x16_bf16 v[16:31], v[220:223], v[60:63], v[16:31]
    s_barrier
    ds_read_b64 v[32:33], v15 offset:0
    ds_read_b64 v[34:35], v15 offset:512
    ds_read_b128 v[36:39], v12 offset:1024
    ds_read_b128 v[40:43], v12 offset:2048
    ds_read_b128 v[44:47], v12 offset:3072
    ds_read_b128 v[48:51], v12 offset:4096
    ds_read_b64 v[52:53], v15 offset:5120
    ds_read_b64 v[54:55], v15 offset:5632
    ds_read_b128 v[56:59], v12 offset:6144
    ds_read_b128 v[60:63], v12 offset:7168
    s_waitcnt lgkmcnt(8)
    v_mfma_f32_32x32x16_bf16 v[16:31], v[224:227], v[32:35], v[16:31]
    s_waitcnt lgkmcnt(7)
    v_mfma_f32_32x32x16_bf16 v[16:31], v[228:231], v[36:39], v[16:31]
    s_waitcnt lgkmcnt(6)
    v_mfma_f32_32x32x16_bf16 v[16:31], v[232:235], v[40:43], v[16:31]
    s_waitcnt lgkmcnt(5)
    v_mfma_f32_32x32x16_bf16 v[16:31], v[236:239], v[44:47], v[16:31]
    s_waitcnt lgkmcnt(4)
    v_mfma_f32_32x32x16_bf16 v[16:31], v[240:243], v[48:51], v[16:31]
    s_waitcnt lgkmcnt(2)
    v_mfma_f32_32x32x16_bf16 v[16:31], v[244:247], v[52:55], v[16:31]
    s_waitcnt lgkmcnt(1)
    v_mfma_f32_32x32x16_bf16 v[16:31], v[248:251], v[56:59], v[16:31]
    s_waitcnt lgkmcnt(0)
    v_mfma_f32_32x32x16_bf16 v[16:31], v[252:255], v[60:63], v[16:31]
    s_barrier
    s_cmp_ge_u32 s23, 64
    s_cbranch_scc1 L_p3_sig
    s_lshl_b32 s24, s35, 7
    s_add_u32 s24, s24, 159744
    v_lshl_add_u32 v8, v4, 5, s24
    ds_read_b128 v[100:103], v8 offset:0
    ds_read_b128 v[104:107], v8 offset:16
    ds_read_b128 v[108:111], v8 offset:256
    ds_read_b128 v[112:115], v8 offset:272
    ds_read_b128 v[116:119], v8 offset:512
    ds_read_b128 v[120:123], v8 offset:528
    ds_read_b128 v[124:127], v8 offset:64
    ds_read_b128 v[128:131], v8 offset:80
    ds_read_b128 v[132:135], v8 offset:320
    ds_read_b128 v[136:139], v8 offset:336
    ds_read_b128 v[140:143], v8 offset:576
    ds_read_b128 v[144:147], v8 offset:592
    s_mul_i32 s24, s23, 40
    s_lshl_b32 s25, s69, 1
    s_add_u32 s24, s24, s25
    s_lshl_b32 s24, s24, 10
    s_add_u32 s25, s24, 12582912
    s_add_u32 s24, s24, 9961472
    s_mov_b32 s26, 0xffff0000
    s_mul_i32 s27, s23, 20
    s_add_u32 s27, s27, s69
    s_lshl_b32 s27, s27, 10
    s_add_u32 s27, s27, 786432
    v_mov_b32 v148, 0
    v_mov_b32 v149, 0
    v_mov_b32 v150, 0
    v_mov_b32 v151, 0
    v_mov_b32 v152, 0
    v_mov_b32 v153, 0
    v_mov_b32 v154, 0
    v_mov_b32 v155, 0
    v_mov_b32 v156, 0
    v_mov_b32 v157, 0
    v_mov_b32 v158, 0
    v_mov_b32 v159, 0
    s_waitcnt vmcnt(0) lgkmcnt(0)
    v_lshlrev_b32 v160, 16, v64
    v_and_b32 v161, s26, v64
    v_pk_fma_f32 v[160:161], v[100:101], v[16:17], v[160:161]
    v_pk_mul_f32 v[162:163], v[160:161], v[108:109]
    v_cvt_pk_bf16_f32 v168, v160, v161
    v_cvt_pk_bf16_f32 v172, v162, v163
    v_pk_add_f32 v[148:149], v[148:149], v[160:161]
    v_pk_fma_f32 v[150:151], v[160:161], v[160:161], v[150:151]
    v_pk_add_f32 v[152:153], v[152:153], v[162:163]
    v_pk_fma_f32 v[154:155], v[162:163], v[162:163], v[154:155]
    v_pk_fma_f32 v[156:157], v[162:163], v[108:109], v[156:157]
    v_pk_fma_f32 v[158:159], v[162:163], v[116:117], v[158:159]
    v_lshlrev_b32 v164, 16, v65
    v_and_b32 v165, s26, v65
    v_pk_fma_f32 v[164:165], v[102:103], v[18:19], v[164:165]
    v_pk_mul_f32 v[166:167], v[164:165], v[110:111]
    v_cvt_pk_bf16_f32 v169, v164, v165
    v_cvt_pk_bf16_f32 v173, v166, v167
    v_pk_add_f32 v[148:149], v[148:149], v[164:165]
    v_pk_fma_f32 v[150:151], v[164:165], v[164:165], v[150:151]
    v_pk_add_f32 v[152:153], v[152:153], v[166:167]
    v_pk_fma_f32 v[154:155], v[166:167], v[166:167], v[154:155]
    v_pk_fma_f32 v[156:157], v[166:167], v[110:111], v[156:157]
    v_pk_fma_f32 v[158:159], v[166:167], v[118:119], v[158:159]
    v_lshlrev_b32 v160, 16, v66
    v_and_b32 v161, s26, v66
    v_pk_fma_f32 v[160:161], v[104:105], v[20:21], v[160:161]
    v_pk_mul_f32 v[162:163], v[160:161], v[112:113]
    v_cvt_pk_bf16_f32 v170, v160, v161
    v_cvt_pk_bf16_f32 v174, v162, v163
    v_pk_add_f32 v[148:149], v[148:149], v[160:161]
    v_pk_fma_f32 v[150:151], v[160:161], v[160:161], v[150:151]
    v_pk_add_f32 v[152:153], v[152:153], v[162:163]
    v_pk_fma_f32 v[154:155], v[162:163], v[162:163], v[154:155]
    v_pk_fma_f32 v[156:157], v[162:163], v[112:113], v[156:157]
    v_pk_fma_f32 v[158:159], v[162:163], v[120:121], v[158:159]
    v_lshlrev_b32 v164, 16, v67
    v_and_b32 v165, s26, v67
    v_pk_fma_f32 v[164:165], v[106:107], v[22:23], v[164:165]
    v_pk_mul_f32 v[166:167], v[164:165], v[114:115]
    v_cvt_pk_bf16_f32 v171, v164, v165
    v_cvt_pk_bf16_f32 v175, v166, v167
    v_pk_add_f32 v[148:149], v[148:149], v[164:165]
    v_pk_fma_f32 v[150:151], v[164:165], v[164:165], v[150:151]
    v_pk_add_f32 v[152:153], v[152:153], v[166:167]
    v_pk_fma_f32 v[154:155], v[166:167], v[166:167], v[154:155]
    v_pk_fma_f32 v[156:157], v[166:167], v[114:115], v[156:157]
    v_pk_fma_f32 v[158:159], v[166:167], v[122:123], v[158:159]
    buffer_store_dwordx4 v[172:175], v2, s[4:7], s25 offen offset:0 sc1
    buffer_store_dwordx4 v[168:171], v2, s[4:7], s24 offen offset:0 sc1
    v_lshlrev_b32 v160, 16, v68
    v_and_b32 v161, s26, v68
    v_pk_fma_f32 v[160:161], v[124:125], v[24:25], v[160:161]
    v_pk_mul_f32 v[162:163], v[160:161], v[132:133]
    v_cvt_pk_bf16_f32 v176, v160, v161
    v_cvt_pk_bf16_f32 v180, v162, v163
    v_pk_add_f32 v[148:149], v[148:149], v[160:161]
    v_pk_fma_f32 v[150:151], v[160:161], v[160:161], v[150:151]
    v_pk_add_f32 v[152:153], v[152:153], v[162:163]
    v_pk_fma_f32 v[154:155], v[162:163], v[162:163], v[154:155]
    v_pk_fma_f32 v[156:157], v[162:163], v[132:133], v[156:157]
    v_pk_fma_f32 v[158:159], v[162:163], v[140:141], v[158:159]
    v_lshlrev_b32 v164, 16, v69
    v_and_b32 v165, s26, v69
    v_pk_fma_f32 v[164:165], v[126:127], v[26:27], v[164:165]
    v_pk_mul_f32 v[166:167], v[164:165], v[134:135]
    v_cvt_pk_bf16_f32 v177, v164, v165
    v_cvt_pk_bf16_f32 v181, v166, v167
    v_pk_add_f32 v[148:149], v[148:149], v[164:165]
    v_pk_fma_f32 v[150:151], v[164:165], v[164:165], v[150:151]
    v_pk_add_f32 v[152:153], v[152:153], v[166:167]
    v_pk_fma_f32 v[154:155], v[166:167], v[166:167], v[154:155]
    v_pk_fma_f32 v[156:157], v[166:167], v[134:135], v[156:157]
    v_pk_fma_f32 v[158:159], v[166:167], v[142:143], v[158:159]
    v_lshlrev_b32 v160, 16, v70
    v_and_b32 v161, s26, v70
    v_pk_fma_f32 v[160:161], v[128:129], v[28:29], v[160:161]
    v_pk_mul_f32 v[162:163], v[160:161], v[136:137]
    v_cvt_pk_bf16_f32 v178, v160, v161
    v_cvt_pk_bf16_f32 v182, v162, v163
    v_pk_add_f32 v[148:149], v[148:149], v[160:161]
    v_pk_fma_f32 v[150:151], v[160:161], v[160:161], v[150:151]
    v_pk_add_f32 v[152:153], v[152:153], v[162:163]
    v_pk_fma_f32 v[154:155], v[162:163], v[162:163], v[154:155]
    v_pk_fma_f32 v[156:157], v[162:163], v[136:137], v[156:157]
    v_pk_fma_f32 v[158:159], v[162:163], v[144:145], v[158:159]
    v_lshlrev_b32 v164, 16, v71
    v_and_b32 v165, s26, v71
    v_pk_fma_f32 v[164:165], v[130:131], v[30:31], v[164:165]
    v_pk_mul_f32 v[166:167], v[164:165], v[138:139]
    v_cvt_pk_bf16_f32 v179, v164, v165
    v_cvt_pk_bf16_f32 v183, v166, v167
    v_pk_add_f32 v[148:149], v[148:149], v[164:165]
    v_pk_fma_f32 v[150:151], v[164:165], v[164:165], v[150:151]
    v_pk_add_f32 v[152:153], v[152:153], v[166:167]
    v_pk_fma_f32 v[154:155], v[166:167], v[166:167], v[154:155]
    v_pk_fma_f32 v[156:157], v[166:167], v[138:139], v[156:157]
    v_pk_fma_f32 v[158:159], v[166:167], v[146:147], v[158:159]
    buffer_store_dwordx4 v[180:183], v2, s[4:7], s25 offen offset:1024 sc1
    buffer_store_dwordx4 v[176:179], v2, s[4:7], s24 offen offset:1024 sc1
    v_add_f32 v32, v148, v149
    v_add_f32 v33, v150, v151
    v_add_f32 v34, v152, v153
    v_add_f32 v35, v154, v155
    v_add_f32 v36, v156, v157
    v_add_f32 v37, v158, v159
    s_nop 1
    v_permlane32_swap_b32 v32, v35
    v_permlane32_swap_b32 v33, v36
    v_permlane32_swap_b32 v34, v37
    v_add_f32 v40, v32, v35
    v_add_f32 v41, v33, v36
    v_add_f32 v42, v34, v37
    v_mov_b32 v43, 0
    buffer_store_dwordx4 v[40:43], v2, s[4:7], s27 offen sc1
L_p3_sig:
    s_barrier
    v_mov_b32 v48, 163788
    v_mov_b32 v49, 1
    s_mov_b64 exec, 1
    s_waitcnt vmcnt(0)
    ds_add_rtn_u32 v50, v48, v49
    s_waitcnt lgkmcnt(0)
    v_readfirstlane_b32 s74, v50
    s_cmp_lg_u32 s74, 5
    s_cbranch_scc1 L_p3_nosig
    s_mov_b64 exec, 0xff
    s_lshl_b32 s74, s68, 7
    s_add_u32 s74, s74, 262144
    v_mov_b32 v48, s76
    v_mov_b32 v49, s77
    v_mov_b32 v50, 0
    v_mov_b32 v51, 0
    buffer_store_dwordx4 v[48:51], v2, s[4:7], s74 offen sc1
L_p3_nosig:
    s_mov_b64 exec, -1
    s_branch L_p3_done
L_p3n_done:
    s_barrier
L_p3_done:
    s_cmp_ge_u32 s67, 28
    s_cbranch_scc1 L_p4_stats
    s_mul_i32 s33, s67, 37
    s_lshr_b32 s33, s33, 8
    s_mul_i32 s22, s33, 7
    s_sub_u32 s22, s67, s22
    s_lshr_b32 s21, s66, 1
    s_lshl_b32 s21, s21, 2
    s_add_u32 s21, s21, s33
    s_and_b32 s20, s66, 1
    s_mul_i32 s20, s20, 7
    s_add_u32 s22, s22, s20
    s_lshl_b32 s33, s21, 2
    s_cmp_lt_u32 s3, 4
    s_cbranch_scc1 L_p4_compute
    s_cmp_eq_u32 s3, 6
    s_cbranch_scc1 L_p4_wload
    s_cmp_eq_u32 s3, 4
    s_cbranch_scc1 L_p4_ext
    s_mul_i32 s12, s33, 40960
    s_sub_u32 s14, 2621440, s12
    s_min_u32 s14, s14, 163840
    s_add_u32 s12, s12, 12582912
    s_add_u32 s12, s64, s12
    s_addc_u32 s13, s65, 0
    s_mov_b32 s15, 0x20000
    s_cmp_eq_u32 s3, 5
    s_cbranch_scc1 L_p4_t5
    v_mov_b32 v8, 163792
    v_mov_b32 v9, 0
    ds_write_b32 v8, v9
    s_waitcnt lgkmcnt(0)
    v_mov_b32 v8, 163796
    v_mov_b32 v9, 0
    ds_write_b32 v8, v9
    s_waitcnt lgkmcnt(0)
    v_mov_b32 v8, 163800
    v_mov_b32 v9, 0
    ds_write_b32 v8, v9
    s_waitcnt lgkmcnt(0)
    s_mul_i32 s28, s33, 43
    s_lshr_b32 s28, s28, 7
    s_mul_i32 s28, s28, 10
    v_min_u32 v8, 19, v1
    v_add_u32 v8, s28, v8
    v_add_u32 v8, 640, v8
    v_lshlrev_b32 v8, 7, v8
    s_mov_b32 s74, 0
    s_mov_b32 s75, 262144
L_p4_poll:
    buffer_load_dwordx2 v[10:11], v8, s[4:7], s75 offen sc1
    s_add_u32 s74, s74, 1
    s_waitcnt vmcnt(0)
    v_cmp_ne_u64 vcc, s[76:77], v[10:11]
    s_cmp_gt_u32 s74, 400000
    s_cbranch_scc1 L_p4_go
    s_nop 2
    s_cbranch_vccz L_p4_go
    s_sleep 1
    s_branch L_p4_poll
L_p4_go:
    s_barrier
    s_mov_b32 s25, 0
    s_mov_b32 s26, 65536
    s_mov_b32 s28, 0
    s_mov_b32 s24, 2
    s_mov_b32 s23, 0
L_p4b_ti:
    s_add_u32 m0, s26, 0
    s_add_u32 s27, s25, 0
    buffer_load_dwordx4 v2, s[12:15], s27 offen sc1 lds
    s_add_u32 m0, s26, 8192
    s_add_u32 s27, s25, 81920
    buffer_load_dwordx4 v2, s[12:15], s27 offen sc1 lds
    s_add_u32 m0, s26, 1024
    s_add_u32 s27, s25, 1024
    buffer_load_dwordx4 v2, s[12:15], s27 offen sc1 lds
    s_add_u32 m0, s26, 9216
    s_add_u32 s27, s25, 82944
    buffer_load_dwordx4 v2, s[12:15], s27 offen sc1 lds
    s_add_u32 m0, s26, 2048
    s_add_u32 s27, s25, 2048
    buffer_load_dwordx4 v2, s[12:15], s27 offen sc1 lds
    s_add_u32 m0, s26, 10240
    s_add_u32 s27, s25, 83968
    buffer_load_dwordx4 v2, s[12:15], s27 offen sc1 lds
    s_add_u32 m0, s26, 3072
    s_add_u32 s27, s25, 3072
    buffer_load_dwordx4 v2, s[12:15], s27 offen sc1 lds
    s_add_u32 m0, s26, 11264
    s_add_u32 s27, s25, 84992
    buffer_load_dwordx4 v2, s[12:15], s27 offen sc1 lds
    s_add_u32 s25, s25, 4096
    s_add_u32 s26, s26, 16384
    s_cmp_eq_u32 s26, 147456
    s_cselect_b32 s26, 65536, s26
    s_add_u32 s28, s28, 1
    s_cmp_lt_u32 s28, s24
    s_cbranch_scc1 L_p4b_ti
    s_cmp_lg_u32 s23, 0
    s_cbranch_scc1 L_p4b_tr1
    s_waitcnt vmcnt(8)
    s_barrier
    s_mov_b32 s24, 4
    s_mov_b32 s23, 1
    s_branch L_p4b_ti
L_p4b_tr1:
    s_cmp_lg_u32 s23, 1
    s_cbranch_scc1 L_p4b_tr2
    s_waitcnt vmcnt(16)
    s_barrier
    s_mov_b32 s24, 6
    s_mov_b32 s23, 2
    s_branch L_p4b_ti
L_p4b_tr2:
    s_cmp_ge_u32 s28, 10
    s_cbranch_scc1 L_p4b_tt
    s_waitcnt vmcnt(24)
    s_barrier
    s_add_u32 s24, s24, 1
    s_branch L_p4b_ti
L_p4b_tt:
    s_waitcnt vmcnt(24)
    s_barrier
    s_waitcnt vmcnt(16)
    s_barrier
    s_waitcnt vmcnt(8)
    s_barrier
    s_waitcnt vmcnt(0)
    s_barrier
    s_barrier
    s_branch L_p4_done
L_p4_t5:
    s_barrier
    s_mov_b32 s25, 0
    s_mov_b32 s26, 65536
    s_mov_b32 s28, 0
    s_mov_b32 s24, 2
    s_mov_b32 s23, 0
L_p4a_ti:
    s_add_u32 m0, s26, 4096
    s_add_u32 s27, s25, 40960
    buffer_load_dwordx4 v2, s[12:15], s27 offen sc1 lds
    s_add_u32 m0, s26, 12288
    s_add_u32 s27, s25, 122880
    buffer_load_dwordx4 v2, s[12:15], s27 offen sc1 lds
    s_add_u32 m0, s26, 5120
    s_add_u32 s27, s25, 41984
    buffer_load_dwordx4 v2, s[12:15], s27 offen sc1 lds
    s_add_u32 m0, s26, 13312
    s_add_u32 s27, s25, 123904
    buffer_load_dwordx4 v2, s[12:15], s27 offen sc1 lds
    s_add_u32 m0, s26, 6144
    s_add_u32 s27, s25, 43008
    buffer_load_dwordx4 v2, s[12:15], s27 offen sc1 lds
    s_add_u32 m0, s26, 14336
    s_add_u32 s27, s25, 124928
    buffer_load_dwordx4 v2, s[12:15], s27 offen sc1 lds
    s_add_u32 m0, s26, 7168
    s_add_u32 s27, s25, 44032
    buffer_load_dwordx4 v2, s[12:15], s27 offen sc1 lds
    s_add_u32 m0, s26, 15360
    s_add_u32 s27, s25, 125952
    buffer_load_dwordx4 v2, s[12:15], s27 offen sc1 lds
    s_add_u32 s25, s25, 4096
    s_add_u32 s26, s26, 16384
    s_cmp_eq_u32 s26, 147456
    s_cselect_b32 s26, 65536, s26
    s_add_u32 s28, s28, 1
    s_cmp_lt_u32 s28, s24
    s_cbranch_scc1 L_p4a_ti
    s_cmp_lg_u32 s23, 0
    s_cbranch_scc1 L_p4a_tr1
    s_waitcnt vmcnt(8)
    s_barrier
    s_mov_b32 s24, 4
    s_mov_b32 s23, 1
    s_branch L_p4a_ti
L_p4a_tr1:
    s_cmp_lg_u32 s23, 1
    s_cbranch_scc1 L_p4a_tr2
    s_waitcnt vmcnt(16)
    s_barrier
    s_mov_b32 s24, 6
    s_mov_b32 s23, 2
    s_branch L_p4a_ti
L_p4a_tr2:
    s_cmp_ge_u32 s28, 10
    s_cbranch_scc1 L_p4a_tt
    s_waitcnt vmcnt(24)
    s_barrier
    s_add_u32 s24, s24, 1
    s_branch L_p4a_ti
L_p4a_tt:
    s_waitcnt vmcnt(24)
    s_barrier
    s_waitcnt vmcnt(16)
    s_barrier
    s_waitcnt vmcnt(8)
    s_barrier
    s_waitcnt vmcnt(0)
    s_barrier
    s_barrier
    s_branch L_p4_done
L_p4_wload:
    s_mov_b32 s8, s48
    s_mov_b32 s9, s49
    s_mov_b32 s10, 2211840
    s_mov_b32 s11, 0x20000
    s_mov_b32 s24, 3456
    v_lshrrev_b32 v9, 4, v1
    v_lshlrev_b32 v10, 2, v9
    v_and_b32 v8, 15, v1
    v_xor_b32 v8, v8, v10
    v_lshlrev_b32 v8, 4, v8
    v_mad_u32_u24 v8, v9, s24, v8
    s_lshl_b32 s34, s22, 8
    v_add_u32 v8, s34, v8
    s_mov_b32 s29, 13824
    s_sub_u32 s25, 0, s29
    s_mov_b32 s26, 0
    s_mov_b32 s28, 0
L_p4_wfill:
    s_mov_b32 m0, s26
    s_add_u32 s25, s25, s29
    buffer_load_dwordx4 v8, s[8:11], s25 offen lds
    s_add_u32 m0, s26, 1024
    s_add_u32 s25, s25, s29
    buffer_load_dwordx4 v8, s[8:11], s25 offen lds
    s_add_u32 m0, s26, 2048
    s_add_u32 s25, s25, s29
    buffer_load_dwordx4 v8, s[8:11], s25 offen lds
    s_add_u32 m0, s26, 3072
    s_add_u32 s25, s25, s29
    buffer_load_dwordx4 v8, s[8:11], s25 offen lds
    s_add_u32 m0, s26, 4096
    s_add_u32 s25, s25, s29
    buffer_load_dwordx4 v8, s[8:11], s25 offen lds
    s_add_u32 m0, s26, 5120
    s_add_u32 s25, s25, s29
    buffer_load_dwordx4 v8, s[8:11], s25 offen lds
    s_add_u32 m0, s26, 6144
    s_add_u32 s25, s25, s29
    buffer_load_dwordx4 v8, s[8:11], s25 offen lds
    s_add_u32 m0, s26, 7168
    s_add_u32 s25, s25, s29
    buffer_load_dwordx4 v8, s[8:11], s25 offen lds
    s_add_u32 m0, s26, 8192
    s_add_u32 s25, s25, s29
    buffer_load_dwordx4 v8, s[8:11], s25 offen lds
    s_add_u32 m0, s26, 9216
    s_add_u32 s25, s25, s29
    buffer_load_dwordx4 v8, s[8:11], s25 offen lds
    s_add_u32 m0, s26, 10240
    s_add_u32 s25, s25, s29
    buffer_load_dwordx4 v8, s[8:11], s25 offen lds
    s_add_u32 m0, s26, 11264
    s_add_u32 s25, s25, s29
    buffer_load_dwordx4 v8, s[8:11], s25 offen lds
    s_add_u32 m0, s26, 12288
    s_add_u32 s25, s25, s29
    buffer_load_dwordx4 v8, s[8:11], s25 offen lds
    s_add_u32 m0, s26, 13312
    s_add_u32 s25, s25, s29
    buffer_load_dwordx4 v8, s[8:11], s25 offen lds
    s_add_u32 m0, s26, 14336
    s_add_u32 s25, s25, s29
    buffer_load_dwordx4 v8, s[8:11], s25 offen lds
    s_add_u32 m0, s26, 15360
    s_add_u32 s25, s25, s29
    buffer_load_dwordx4 v8, s[8:11], s25 offen lds
    s_add_u32 s26, s26, 16384
    s_cmp_eq_u32 s26, 65536
    s_cselect_b32 s26, 0, s26
    s_add_u32 s28, s28, 1
    s_cmp_lt_u32 s28, 4
    s_cbranch_scc1 L_p4_wfill
    s_barrier
    s_waitcnt vmcnt(48)
    s_barrier
    s_mov_b32 s28, 0
L_p4_wloop:
    s_waitcnt vmcnt(32)
    s_barrier
    s_mov_b32 m0, s26
    s_add_u32 s25, s25, s29
    buffer_load_dwordx4 v8, s[8:11], s25 offen lds
    s_add_u32 m0, s26, 1024
    s_add_u32 s25, s25, s29
    buffer_load_dwordx4 v8, s[8:11], s25 offen lds
    s_add_u32 m0, s26, 2048
    s_add_u32 s25, s25, s29
    buffer_load_dwordx4 v8, s[8:11], s25 offen lds
    s_add_u32 m0, s26, 3072
    s_add_u32 s25, s25, s29
    buffer_load_dwordx4 v8, s[8:11], s25 offen lds
    s_add_u32 m0, s26, 4096
    s_add_u32 s25, s25, s29
    buffer_load_dwordx4 v8, s[8:11], s25 offen lds
    s_add_u32 m0, s26, 5120
    s_add_u32 s25, s25, s29
    buffer_load_dwordx4 v8, s[8:11], s25 offen lds
    s_add_u32 m0, s26, 6144
    s_add_u32 s25, s25, s29
    buffer_load_dwordx4 v8, s[8:11], s25 offen lds
    s_add_u32 m0, s26, 7168
    s_add_u32 s25, s25, s29
    buffer_load_dwordx4 v8, s[8:11], s25 offen lds
    s_add_u32 m0, s26, 8192
    s_add_u32 s25, s25, s29
    buffer_load_dwordx4 v8, s[8:11], s25 offen lds
    s_add_u32 m0, s26, 9216
    s_add_u32 s25, s25, s29
    buffer_load_dwordx4 v8, s[8:11], s25 offen lds
    s_add_u32 m0, s26, 10240
    s_add_u32 s25, s25, s29
    buffer_load_dwordx4 v8, s[8:11], s25 offen lds
    s_add_u32 m0, s26, 11264
    s_add_u32 s25, s25, s29
    buffer_load_dwordx4 v8, s[8:11], s25 offen lds
    s_add_u32 m0, s26, 12288
    s_add_u32 s25, s25, s29
    buffer_load_dwordx4 v8, s[8:11], s25 offen lds
    s_add_u32 m0, s26, 13312
    s_add_u32 s25, s25, s29
    buffer_load_dwordx4 v8, s[8:11], s25 offen lds
    s_add_u32 m0, s26, 14336
    s_add_u32 s25, s25, s29
    buffer_load_dwordx4 v8, s[8:11], s25 offen lds
    s_add_u32 m0, s26, 15360
    s_add_u32 s25, s25, s29
    buffer_load_dwordx4 v8, s[8:11], s25 offen lds
    s_add_u32 s26, s26, 16384
    s_cmp_eq_u32 s26, 65536
    s_cselect_b32 s26, 0, s26
    s_add_u32 s28, s28, 1
    s_cmp_lt_u32 s28, 6
    s_cbranch_scc1 L_p4_wloop
    s_waitcnt vmcnt(32)
    s_barrier
    s_waitcnt vmcnt(16)
    s_barrier
    s_waitcnt vmcnt(0)
    s_barrier
    s_barrier
    s_branch L_p4_done
L_p4_ext:
    v_add_u32 v8, s33, v1
    v_add_u32 v8, 1184, v8
    s_lshl_b32 s29, s22, 1
    v_subrev_u32 v9, 4, v1
    v_min_u32 v9, 1, v9
    v_add_u32 v9, s29, v9
    v_min_u32 v9, 26, v9
    v_add_u32 v9, 1152, v9
    v_cmp_gt_u32 vcc, 4, v1
    s_mov_b32 s28, 0
    s_mov_b32 s75, 262144
    v_cndmask_b32 v8, v9, v8, vcc
    v_lshlrev_b32 v12, 7, v8
    s_barrier
    s_barrier
    s_barrier
    s_barrier
    s_barrier
    s_barrier
    s_barrier
    s_barrier
    buffer_load_dwordx2 v[10:11], v12, s[4:7], s75 offen sc1
    s_barrier
    s_barrier
    s_waitcnt vmcnt(0)
    v_cmp_ne_u64 vcc, s[76:77], v[10:11]
    s_nop 4
    s_cbranch_vccz L_p4e_go
    v_lshlrev_b32 v8, 7, v8
    s_mov_b32 s74, 0
    s_mov_b32 s75, 262144
L_p4e_poll:
    buffer_load_dwordx2 v[10:11], v8, s[4:7], s75 offen sc1
    s_add_u32 s74, s74, 1
    s_waitcnt vmcnt(0)
    v_cmp_ne_u64 vcc, s[76:77], v[10:11]
    s_cmp_gt_u32 s74, 400000
    s_cbranch_scc1 L_p4e_go
    s_nop 2
    s_cbranch_vccz L_p4e_go
    s_sleep 1
    s_branch L_p4e_poll
L_p4e_go:
    s_mul_i32 s24, s33, 1536
    s_add_u32 s24, s24, 65536
    s_lshl_b32 s25, s22, 12
    s_add_u32 s25, s25, 196608
    s_mov_b32 m0, 147456
    s_add_u32 s26, s24, 4096
    buffer_load_dwordx4 v2, s[4:7], s24 offen offset:0 sc1 lds
    buffer_load_dwordx4 v2, s[4:7], s24 offen offset:1024 sc1 lds
    buffer_load_dwordx4 v2, s[4:7], s24 offen offset:2048 sc1 lds
    buffer_load_dwordx4 v2, s[4:7], s24 offen offset:3072 sc1 lds
    s_mov_b32 m0, 151552
    s_nop 0
    buffer_load_dwordx4 v2, s[4:7], s26 offen offset:0 sc1 lds
    buffer_load_dwordx4 v2, s[4:7], s26 offen offset:1024 sc1 lds
    s_mov_b32 m0, 153600
    s_nop 0
    buffer_load_dwordx4 v2, s[4:7], s25 offen offset:0 sc1 lds
    buffer_load_dwordx4 v2, s[4:7], s25 offen offset:1024 sc1 lds
    buffer_load_dwordx4 v2, s[4:7], s25 offen offset:2048 sc1 lds
    buffer_load_dwordx4 v2, s[4:7], s25 offen offset:3072 sc1 lds
    s_barrier
    s_waitcnt vmcnt(0)
    s_barrier
    s_branch L_p4_done
L_p4_stats:
    s_cmp_ge_u32 s3, 2
    s_cbranch_scc1 L_p4_done
    s_sub_u32 s23, s2, 224
    s_lshl_b32 s23, s23, 1
    s_add_u32 s23, s23, s3
    s_mul_i32 s28, s23, 43
    s_lshr_b32 s28, s28, 7
    s_mul_i32 s28, s28, 10
    v_add_u32 v8, s28, v1
    v_add_u32 v8, 640, v8
    v_mov_b32 v9, 1179
    v_cmp_gt_u32 vcc, 10, v1
    s_nop 1
    v_cndmask_b32 v8, v9, v8, vcc
    v_lshlrev_b32 v8, 7, v8
    s_mov_b32 s74, 0
    s_mov_b32 s75, 262144
L_p4s_poll:
    buffer_load_dwordx2 v[10:11], v8, s[4:7], s75 offen sc1
    s_add_u32 s74, s74, 1
    s_waitcnt vmcnt(0)
    v_cmp_ne_u64 vcc, s[76:77], v[10:11]
    s_cmp_gt_u32 s74, 400000
    s_cbranch_scc1 L_p4s_go
    s_nop 2
    s_cbranch_vccz L_p4s_go
    s_sleep 1
    s_branch L_p4s_poll
L_p4s_go:
    v_mov_b32 v8, 0
    s_mov_b32 s24, 28672
    buffer_load_dwordx4 v[12:15], v8, s[4:7], s24 offen sc1
    buffer_load_dword v16, v8, s[4:7], s24 offen offset:16 sc1
    s_mul_i32 s24, s23, 20480
    s_add_u32 s24, s24, 786432
    buffer_load_dwordx4 v[20:23], v2, s[4:7], s24 offen offset:0 sc1
    buffer_load_dwordx4 v[24:27], v2, s[4:7], s24 offen offset:1024 sc1
    buffer_load_dwordx4 v[28:31], v2, s[4:7], s24 offen offset:2048 sc1
    buffer_load_dwordx4 v[32:35], v2, s[4:7], s24 offen offset:3072 sc1
    s_add_u32 s24, s24, 4096
    buffer_load_dwordx4 v[36:39], v2, s[4:7], s24 offen offset:0 sc1
    buffer_load_dwordx4 v[40:43], v2, s[4:7], s24 offen offset:1024 sc1
    buffer_load_dwordx4 v[44:47], v2, s[4:7], s24 offen offset:2048 sc1
    buffer_load_dwordx4 v[48:51], v2, s[4:7], s24 offen offset:3072 sc1
    s_add_u32 s24, s24, 4096
    buffer_load_dwordx4 v[52:55], v2, s[4:7], s24 offen offset:0 sc1
    buffer_load_dwordx4 v[56:59], v2, s[4:7], s24 offen offset:1024 sc1
    buffer_load_dwordx4 v[60:63], v2, s[4:7], s24 offen offset:2048 sc1
    buffer_load_dwordx4 v[64:67], v2, s[4:7], s24 offen offset:3072 sc1
    s_add_u32 s24, s24, 4096
    buffer_load_dwordx4 v[68:71], v2, s[4:7], s24 offen offset:0 sc1
    buffer_load_dwordx4 v[72:75], v2, s[4:7], s24 offen offset:1024 sc1
    buffer_load_dwordx4 v[76:79], v2, s[4:7], s24 offen offset:2048 sc1
    buffer_load_dwordx4 v[80:83], v2, s[4:7], s24 offen offset:3072 sc1
    s_add_u32 s24, s24, 4096
    buffer_load_dwordx4 v[84:87], v2, s[4:7], s24 offen offset:0 sc1
    buffer_load_dwordx4 v[88:91], v2, s[4:7], s24 offen offset:1024 sc1
    buffer_load_dwordx4 v[92:95], v2, s[4:7], s24 offen offset:2048 sc1
    buffer_load_dwordx4 v[96:99], v2, s[4:7], s24 offen offset:3072 sc1
    s_waitcnt vmcnt(0) lgkmcnt(0)
    v_add_f32 v20, v20, v60
    v_add_f32 v21, v21, v61
    v_add_f32 v22, v22, v62
    v_add_f32 v24, v24, v64
    v_add_f32 v25, v25, v65
    v_add_f32 v26, v26, v66
    v_add_f32 v28, v28, v68
    v_add_f32 v29, v29, v69
    v_add_f32 v30, v30, v70
    v_add_f32 v32, v32, v72
    v_add_f32 v33, v33, v73
    v_add_f32 v34, v34, v74
    v_add_f32 v36, v36, v76
    v_add_f32 v37, v37, v77
    v_add_f32 v38, v38, v78
    v_add_f32 v40, v40, v80
    v_add_f32 v41, v41, v81
    v_add_f32 v42, v42, v82
    v_add_f32 v44, v44, v84
    v_add_f32 v45, v45, v85
    v_add_f32 v46, v46, v86
    v_add_f32 v48, v48, v88
    v_add_f32 v49, v49, v89
    v_add_f32 v50, v50, v90
    v_add_f32 v52, v52, v92
    v_add_f32 v53, v53, v93
    v_add_f32 v54, v54, v94
    v_add_f32 v56, v56, v96
    v_add_f32 v57, v57, v97
    v_add_f32 v58, v58, v98
    v_add_f32 v20, v20, v40
    v_add_f32 v21, v21, v41
    v_add_f32 v22, v22, v42
    v_add_f32 v24, v24, v44
    v_add_f32 v25, v25, v45
    v_add_f32 v26, v26, v46
    v_add_f32 v28, v28, v48
    v_add_f32 v29, v29, v49
    v_add_f32 v30, v30, v50
    v_add_f32 v32, v32, v52
    v_add_f32 v33, v33, v53
    v_add_f32 v34, v34, v54
    v_add_f32 v36, v36, v56
    v_add_f32 v37, v37, v57
    v_add_f32 v38, v38, v58
    v_add_f32 v20, v20, v24
    v_add_f32 v28, v28, v32
    v_add_f32 v21, v21, v25
    v_add_f32 v29, v29, v33
    v_add_f32 v22, v22, v26
    v_add_f32 v30, v30, v34
    v_add_f32 v20, v20, v28
    v_add_f32 v20, v20, v36
    v_add_f32 v21, v21, v29
    v_add_f32 v21, v21, v37
    v_add_f32 v22, v22, v30
    v_add_f32 v22, v22, v38
    v_mul_f32 v20, 0x3acccccd, v20
    v_mov_b32 v23, v20
    v_mul_f32 v21, 0x3acccccd, v21
    v_mov_b32 v24, v21
    v_mul_f32 v22, 0x3acccccd, v22
    v_mov_b32 v25, v22
    s_nop 1
    v_permlane32_swap_b32 v20, v23
    v_permlane32_swap_b32 v21, v24
    v_permlane32_swap_b32 v22, v25
    v_fma_f32 v40, -v20, v20, v21
    v_max_f32 v40, 0, v40
    v_add_f32 v40, 0x3727c5ac, v40
    v_rsq_f32 v41, v40
    v_sqrt_f32 v42, v40
    v_mul_f32 v43, v12, v20
    v_sub_f32 v43, v22, v43
    v_mul_f32 v44, v13, v20
    v_fma_f32 v44, -2.0, v24, v44
    v_fma_f32 v44, v20, v44, v23
    v_mul_f32 v45, v16, v20
    v_sub_f32 v45, v25, v45
    v_mov_b32 v46, v14
    v_fma_f32 v46, v41, v43, v46
    v_mul_f32 v47, v41, v44
    v_fma_f32 v47, 2.0, v45, v47
    v_mov_b32 v48, v15
    v_fma_f32 v47, v41, v47, v48
    v_fma_f32 v47, -v46, v46, v47
    v_max_f32 v47, 0, v47
    v_add_f32 v47, 0x3727c5ac, v47
    v_rsq_f32 v48, v47
    v_sqrt_f32 v49, v47
    s_nop 0
    v_mul_f32 v54, v41, v48
    v_sub_f32 v50, 0, v20
    v_mov_b32 v51, v42
    v_mul_f32 v52, v46, v42
    v_sub_f32 v52, 0, v52
    v_mul_f32 v53, v42, v49
    v_mov_b32 v55, v53
    s_mov_b32 s26, 0xffff0000
    s_mov_b32 s27, 0xffff
    v_cvt_pk_bf16_f32 v56, v50, v50
    v_and_b32 v64, s26, v56
    v_sub_f32 v64, v50, v64
    v_cvt_pk_bf16_f32 v60, v64, v64
    v_cvt_pk_bf16_f32 v57, v51, v51
    v_and_b32 v64, s26, v57
    v_sub_f32 v64, v51, v64
    v_cvt_pk_bf16_f32 v61, v64, v64
    v_cvt_pk_bf16_f32 v58, v52, v52
    v_and_b32 v64, s26, v58
    v_sub_f32 v64, v52, v64
    v_cvt_pk_bf16_f32 v62, v64, v64
    v_cvt_pk_bf16_f32 v59, v53, v53
    v_and_b32 v64, s26, v59
    v_sub_f32 v64, v53, v64
    v_cvt_pk_bf16_f32 v63, v64, v64
    v_bfi_b32 v66, s27, v56, v60
    v_bfi_b32 v67, s27, v56, v57
    v_bfi_b32 v68, s27, v61, v57
    v_bfi_b32 v69, s27, v58, v62
    v_bfi_b32 v70, s27, v58, v59
    v_and_b32 v71, s27, v63
    v_cmp_gt_u32 vcc, 32, v1
    s_mul_i32 s24, s23, 1536
    s_add_u32 s24, s24, 65536
    v_cndmask_b32 v72, v70, v66, vcc
    v_cndmask_b32 v73, v71, v67, vcc
    v_cndmask_b32 v74, 0, v68, vcc
    v_cndmask_b32 v75, 0, v69, vcc
    v_lshlrev_b32 v9, 3, v1
    buffer_store_dwordx4 v[72:75], v2, s[4:7], s24 offen sc1
    buffer_store_dwordx2 v[54:55], v9, s[4:7], s24 offen offset:1024 sc1
    s_add_u32 s24, s23, 1184
    s_waitcnt vmcnt(0)
    s_mov_b64 exec, 1
    s_mov_b64 exec, 0xff
    s_lshl_b32 s74, s24, 7
    s_add_u32 s74, s74, 262144
    v_mov_b32 v10, s76
    v_mov_b32 v11, s77
    v_mov_b32 v12, 0
    v_mov_b32 v13, 0
    buffer_store_dwordx4 v[10:13], v2, s[4:7], s74 offen sc1
    s_mov_b64 exec, -1
    s_branch L_p4_done
L_p4_compute:
    s_add_u32 s23, s33, s3
    s_mul_i32 s68, s21, 14
    s_add_u32 s68, s68, s22
    s_add_u32 s68, s68, 896
    v_bfe_u32 v18, v1, 2, 2
    v_lshl_add_u32 v19, v4, 3, v18
    v_mul_u32_u24 v8, 256, v19
    v_xor_b32 v18, 0, v18
    v_lshl_add_u32 v8, v18, 6, v8
    v_bfe_u32 v18, v1, 4, 1
    v_lshl_add_u32 v8, v18, 5, v8
    v_and_b32 v18, 1, v1
    v_lshl_add_u32 v8, v18, 4, v8
    v_bfe_u32 v18, v1, 1, 1
    v_lshl_add_u32 v8, v18, 3, v8
    v_bfe_u32 v18, v1, 2, 2
    v_lshl_add_u32 v19, v4, 3, v18
    v_mul_u32_u24 v9, 256, v19
    v_xor_b32 v18, 1, v18
    v_lshl_add_u32 v9, v18, 6, v9
    v_bfe_u32 v18, v1, 4, 1
    v_lshl_add_u32 v9, v18, 5, v9
    v_and_b32 v18, 1, v1
    v_lshl_add_u32 v9, v18, 4, v9
    v_bfe_u32 v18, v1, 1, 1
    v_lshl_add_u32 v9, v18, 3, v9
    v_bfe_u32 v18, v1, 2, 2
    v_lshl_add_u32 v19, v4, 3, v18
    v_mul_u32_u24 v10, 256, v19
    v_xor_b32 v18, 2, v18
    v_lshl_add_u32 v10, v18, 6, v10
    v_bfe_u32 v18, v1, 4, 1
    v_lshl_add_u32 v10, v18, 5, v10
    v_and_b32 v18, 1, v1
    v_lshl_add_u32 v10, v18, 4, v10
    v_bfe_u32 v18, v1, 1, 1
    v_lshl_add_u32 v10, v18, 3, v10
    v_bfe_u32 v18, v1, 2, 2
    v_lshl_add_u32 v19, v4, 3, v18
    v_mul_u32_u24 v11, 256, v19
    v_xor_b32 v18, 3, v18
    v_lshl_add_u32 v11, v18, 6, v11
    v_bfe_u32 v18, v1, 4, 1
    v_lshl_add_u32 v11, v18, 5, v11
    v_and_b32 v18, 1, v1
    v_lshl_add_u32 v11, v18, 4, v11
    v_bfe_u32 v18, v1, 1, 1
    v_lshl_add_u32 v11, v18, 3, v11
    s_mul_i32 s30, s3, 4096
    v_add_u32 v16, s30, v2
    v_mov_b32 v20, 0
    v_mov_b32 v21, 0
    v_mov_b32 v22, 0
    v_mov_b32 v23, 0
    v_mov_b32 v24, 0
    v_mov_b32 v25, 0
    v_mov_b32 v26, 0
    v_mov_b32 v27, 0
    v_mov_b32 v28, 0
    v_mov_b32 v29, 0
    v_mov_b32 v30, 0
    v_mov_b32 v31, 0
    v_mov_b32 v32, 0
    v_mov_b32 v33, 0
    v_mov_b32 v34, 0
    v_mov_b32 v35, 0
    v_mov_b32 v36, 0
    v_mov_b32 v37, 0
    v_mov_b32 v38, 0
    v_mov_b32 v39, 0
    v_mov_b32 v40, 0
    v_mov_b32 v41, 0
    v_mov_b32 v42, 0
    v_mov_b32 v43, 0
    v_mov_b32 v44, 0
    v_mov_b32 v45, 0
    v_mov_b32 v46, 0
    v_mov_b32 v47, 0
    v_mov_b32 v48, 0
    v_mov_b32 v49, 0
    v_mov_b32 v50, 0
    v_mov_b32 v51, 0
    v_mov_b32 v52, 0
    v_mov_b32 v53, 0
    v_mov_b32 v54, 0
    v_mov_b32 v55, 0
    v_mov_b32 v56, 0
    v_mov_b32 v57, 0
    v_mov_b32 v58, 0
    v_mov_b32 v59, 0
    v_mov_b32 v60, 0
    v_mov_b32 v61, 0
    v_mov_b32 v62, 0
    v_mov_b32 v63, 0
    v_mov_b32 v64, 0
    v_mov_b32 v65, 0
    v_mov_b32 v66, 0
    v_mov_b32 v67, 0
    v_mov_b32 v68, 0
    v_mov_b32 v69, 0
    v_mov_b32 v70, 0
    v_mov_b32 v71, 0
    v_mov_b32 v72, 0
    v_mov_b32 v73, 0
    v_mov_b32 v74, 0
    v_mov_b32 v75, 0
    v_mov_b32 v76, 0
    v_mov_b32 v77, 0
    v_mov_b32 v78, 0
    v_mov_b32 v79, 0
    v_mov_b32 v80, 0
    v_mov_b32 v81, 0
    v_mov_b32 v82, 0
    v_mov_b32 v83, 0
    s_mov_b32 s31, 0
    s_mov_b32 s32, 65536
    v_add_u32 v12, s31, v8
    v_add_u32 v13, s31, v9
    v_add_u32 v14, s31, v10
    v_add_u32 v15, s31, v11
    v_add_u32 v17, s32, v16
    s_add_u32 s31, s31, 16384
    s_cmp_eq_u32 s31, 65536
    s_cselect_b32 s31, 0, s31
    s_add_u32 s32, s32, 16384
    s_cmp_eq_u32 s32, 147456
    s_cselect_b32 s32, 65536, s32
    s_barrier
    s_barrier
    ds_read_b128 v[84:87], v17 offset:0
    ds_read_b64_tr_b16 v[116:117], v12 offset:0
    ds_read_b64_tr_b16 v[118:119], v12 offset:1024
    ds_read_b64_tr_b16 v[120:121], v13 offset:0
    ds_read_b64_tr_b16 v[122:123], v13 offset:1024
    ds_read_b64_tr_b16 v[124:125], v14 offset:0
    ds_read_b64_tr_b16 v[126:127], v14 offset:1024
    ds_read_b64_tr_b16 v[128:129], v15 offset:0
    ds_read_b64_tr_b16 v[130:131], v15 offset:1024
    ds_read_b128 v[88:91], v17 offset:1024
    ds_read_b64_tr_b16 v[132:133], v12 offset:4096
    ds_read_b64_tr_b16 v[134:135], v12 offset:5120
    ds_read_b64_tr_b16 v[136:137], v13 offset:4096
    ds_read_b64_tr_b16 v[138:139], v13 offset:5120
    ds_read_b64_tr_b16 v[140:141], v14 offset:4096
    ds_read_b64_tr_b16 v[142:143], v14 offset:5120
    ds_read_b64_tr_b16 v[144:145], v15 offset:4096
    ds_read_b64_tr_b16 v[146:147], v15 offset:5120
    s_mov_b32 s28, 0
L_p4_loop:
    s_waitcnt lgkmcnt(9)
    v_mfma_f32_32x32x16_bf16 v[20:35], v[116:119], v[84:87], v[20:35]
    ds_read_b128 v[92:95], v17 offset:2048
    ds_read_b64_tr_b16 v[148:149], v12 offset:8192
    ds_read_b64_tr_b16 v[150:151], v12 offset:9216
    v_mfma_f32_32x32x16_bf16 v[36:51], v[120:123], v[84:87], v[36:51]
    ds_read_b64_tr_b16 v[152:153], v13 offset:8192
    ds_read_b64_tr_b16 v[154:155], v13 offset:9216
    ds_read_b64_tr_b16 v[156:157], v14 offset:8192
    v_mfma_f32_32x32x16_bf16 v[52:67], v[124:127], v[84:87], v[52:67]
    ds_read_b64_tr_b16 v[158:159], v14 offset:9216
    ds_read_b64_tr_b16 v[160:161], v15 offset:8192
    ds_read_b64_tr_b16 v[162:163], v15 offset:9216
    v_mfma_f32_32x32x16_bf16 v[68:83], v[128:131], v[84:87], v[68:83]
    s_waitcnt lgkmcnt(9)
    v_mfma_f32_32x32x16_bf16 v[20:35], v[132:135], v[88:91], v[20:35]
    ds_read_b128 v[96:99], v17 offset:3072
    ds_read_b64_tr_b16 v[164:165], v12 offset:12288
    ds_read_b64_tr_b16 v[166:167], v12 offset:13312
    v_mfma_f32_32x32x16_bf16 v[36:51], v[136:139], v[88:91], v[36:51]
    ds_read_b64_tr_b16 v[168:169], v13 offset:12288
    ds_read_b64_tr_b16 v[170:171], v13 offset:13312
    ds_read_b64_tr_b16 v[172:173], v14 offset:12288
    v_mfma_f32_32x32x16_bf16 v[52:67], v[140:143], v[88:91], v[52:67]
    ds_read_b64_tr_b16 v[174:175], v14 offset:13312
    ds_read_b64_tr_b16 v[176:177], v15 offset:12288
    ds_read_b64_tr_b16 v[178:179], v15 offset:13312
    v_mfma_f32_32x32x16_bf16 v[68:83], v[144:147], v[88:91], v[68:83]
    s_waitcnt lgkmcnt(9)
    v_mfma_f32_32x32x16_bf16 v[20:35], v[148:151], v[92:95], v[20:35]
    s_waitcnt lgkmcnt(0)
    v_add_u32 v12, s31, v8
    v_add_u32 v13, s31, v9
    v_add_u32 v14, s31, v10
    v_add_u32 v15, s31, v11
    v_add_u32 v17, s32, v16
    s_add_u32 s31, s31, 16384
    s_cmp_eq_u32 s31, 65536
    s_cselect_b32 s31, 0, s31
    s_add_u32 s32, s32, 16384
    s_cmp_eq_u32 s32, 147456
    s_cselect_b32 s32, 65536, s32
    s_barrier
    v_mfma_f32_32x32x16_bf16 v[36:51], v[152:155], v[92:95], v[36:51]
    ds_read_b128 v[84:87], v17 offset:0
    ds_read_b64_tr_b16 v[116:117], v12 offset:0
    ds_read_b64_tr_b16 v[118:119], v12 offset:1024
    v_mfma_f32_32x32x16_bf16 v[52:67], v[156:159], v[92:95], v[52:67]
    ds_read_b64_tr_b16 v[120:121], v13 offset:0
    ds_read_b64_tr_b16 v[122:123], v13 offset:1024
    ds_read_b64_tr_b16 v[124:125], v14 offset:0
    v_mfma_f32_32x32x16_bf16 v[68:83], v[160:163], v[92:95], v[68:83]
    ds_read_b64_tr_b16 v[126:127], v14 offset:1024
    ds_read_b64_tr_b16 v[128:129], v15 offset:0
    ds_read_b64_tr_b16 v[130:131], v15 offset:1024
    s_waitcnt lgkmcnt(9)
    v_mfma_f32_32x32x16_bf16 v[20:35], v[164:167], v[96:99], v[20:35]
    ds_read_b128 v[88:91], v17 offset:1024
    ds_read_b64_tr_b16 v[132:133], v12 offset:4096
    ds_read_b64_tr_b16 v[134:135], v12 offset:5120
    v_mfma_f32_32x32x16_bf16 v[36:51], v[168:171], v[96:99], v[36:51]
    ds_read_b64_tr_b16 v[136:137], v13 offset:4096
    ds_read_b64_tr_b16 v[138:139], v13 offset:5120
    ds_read_b64_tr_b16 v[140:141], v14 offset:4096
    v_mfma_f32_32x32x16_bf16 v[52:67], v[172:175], v[96:99], v[52:67]
    ds_read_b64_tr_b16 v[142:143], v14 offset:5120
    ds_read_b64_tr_b16 v[144:145], v15 offset:4096
    ds_read_b64_tr_b16 v[146:147], v15 offset:5120
    v_mfma_f32_32x32x16_bf16 v[68:83], v[176:179], v[96:99], v[68:83]
    s_add_u32 s28, s28, 1
    s_cmp_lt_u32 s28, 10
    s_cbranch_scc1 L_p4_loop
    s_waitcnt lgkmcnt(0)
    v_add_u32 v10, 153600, v2
    ds_read_b128 v[84:87], v10
    ds_read_b128 v[88:91], v10 offset:1024
    ds_read_b128 v[92:95], v10 offset:2048
    ds_read_b128 v[96:99], v10 offset:3072
    s_mul_i32 s24, s3, 1536
    s_add_u32 s24, s24, 147456
    v_add_u32 v8, s24, v2
    v_lshlrev_b32 v9, 3, v1
    v_add_u32 v9, s24, v9
    ds_read_b128 v[112:115], v8
    ds_read_b64 v[100:101], v9 offset:1024
    s_mul_i32 s24, s23, 108
    s_lshl_b32 s25, s22, 2
    s_add_u32 s24, s24, s25
    s_lshl_b32 s24, s24, 10
    s_add_u32 s24, s24, 15204352
    s_waitcnt lgkmcnt(0)
    v_mfma_f32_32x32x16_bf16 v[20:35], v[84:87], v[112:115], v[20:35]
    v_mfma_f32_32x32x16_bf16 v[36:51], v[88:91], v[112:115], v[36:51]
    v_mfma_f32_32x32x16_bf16 v[52:67], v[92:95], v[112:115], v[52:67]
    v_mfma_f32_32x32x16_bf16 v[68:83], v[96:99], v[112:115], v[68:83]
    v_mul_f32 v102, 0xc0135761, v100
    v_mul_f32 v104, v100, v100
    v_mul_f32 v104, v104, v100
    v_mul_f32 v104, 0xbdd2d3e8, v104
    v_mov_b32 v103, v102
    v_mov_b32 v105, v104
    v_mov_b32 v106, v101
    v_mov_b32 v107, v101
    s_nop 1
    v_pk_mul_f32 v[116:117], v[20:21], v[20:21]
    v_pk_mul_f32 v[118:119], v[22:23], v[22:23]
    v_pk_mul_f32 v[120:121], v[24:25], v[24:25]
    v_pk_mul_f32 v[122:123], v[26:27], v[26:27]
    v_pk_fma_f32 v[116:117], v[116:117], v[104:105], v[102:103]
    v_pk_fma_f32 v[118:119], v[118:119], v[104:105], v[102:103]
    v_pk_fma_f32 v[120:121], v[120:121], v[104:105], v[102:103]
    v_pk_fma_f32 v[122:123], v[122:123], v[104:105], v[102:103]
    v_pk_mul_f32 v[116:117], v[116:117], v[20:21]
    v_pk_mul_f32 v[118:119], v[118:119], v[22:23]
    v_pk_mul_f32 v[120:121], v[120:121], v[24:25]
    v_pk_mul_f32 v[122:123], v[122:123], v[26:27]
    v_exp_f32 v116, v116
    v_exp_f32 v117, v117
    v_exp_f32 v118, v118
    v_exp_f32 v119, v119
    v_exp_f32 v120, v120
    v_exp_f32 v121, v121
    v_exp_f32 v122, v122
    v_exp_f32 v123, v123
    v_pk_fma_f32 v[116:117], v[116:117], v[106:107], v[106:107]
    v_pk_fma_f32 v[118:119], v[118:119], v[106:107], v[106:107]
    v_pk_fma_f32 v[120:121], v[120:121], v[106:107], v[106:107]
    v_pk_fma_f32 v[122:123], v[122:123], v[106:107], v[106:107]
    v_rcp_f32 v116, v116
    v_rcp_f32 v117, v117
    v_rcp_f32 v118, v118
    v_rcp_f32 v119, v119
    v_rcp_f32 v120, v120
    v_rcp_f32 v121, v121
    v_rcp_f32 v122, v122
    v_rcp_f32 v123, v123
    v_pk_mul_f32 v[20:21], v[20:21], v[116:117]
    v_pk_mul_f32 v[22:23], v[22:23], v[118:119]
    v_pk_mul_f32 v[24:25], v[24:25], v[120:121]
    v_pk_mul_f32 v[26:27], v[26:27], v[122:123]
    v_cvt_pk_bf16_f32 v132, v20, v21
    v_cvt_pk_bf16_f32 v133, v22, v23
    v_cvt_pk_bf16_f32 v134, v24, v25
    v_cvt_pk_bf16_f32 v135, v26, v27
    buffer_store_dwordx4 v[132:135], v2, s[4:7], s24 offen offset:0 sc1
    v_pk_mul_f32 v[124:125], v[28:29], v[28:29]
    v_pk_mul_f32 v[126:127], v[30:31], v[30:31]
    v_pk_mul_f32 v[128:129], v[32:33], v[32:33]
    v_pk_mul_f32 v[130:131], v[34:35], v[34:35]
    v_pk_fma_f32 v[124:125], v[124:125], v[104:105], v[102:103]
    v_pk_fma_f32 v[126:127], v[126:127], v[104:105], v[102:103]
    v_pk_fma_f32 v[128:129], v[128:129], v[104:105], v[102:103]
    v_pk_fma_f32 v[130:131], v[130:131], v[104:105], v[102:103]
    v_pk_mul_f32 v[124:125], v[124:125], v[28:29]
    v_pk_mul_f32 v[126:127], v[126:127], v[30:31]
    v_pk_mul_f32 v[128:129], v[128:129], v[32:33]
    v_pk_mul_f32 v[130:131], v[130:131], v[34:35]
    v_exp_f32 v124, v124
    v_exp_f32 v125, v125
    v_exp_f32 v126, v126
    v_exp_f32 v127, v127
    v_exp_f32 v128, v128
    v_exp_f32 v129, v129
    v_exp_f32 v130, v130
    v_exp_f32 v131, v131
    v_pk_fma_f32 v[124:125], v[124:125], v[106:107], v[106:107]
    v_pk_fma_f32 v[126:127], v[126:127], v[106:107], v[106:107]
    v_pk_fma_f32 v[128:129], v[128:129], v[106:107], v[106:107]
    v_pk_fma_f32 v[130:131], v[130:131], v[106:107], v[106:107]
    v_rcp_f32 v124, v124
    v_rcp_f32 v125, v125
    v_rcp_f32 v126, v126
    v_rcp_f32 v127, v127
    v_rcp_f32 v128, v128
    v_rcp_f32 v129, v129
    v_rcp_f32 v130, v130
    v_rcp_f32 v131, v131
    v_pk_mul_f32 v[28:29], v[28:29], v[124:125]
    v_pk_mul_f32 v[30:31], v[30:31], v[126:127]
    v_pk_mul_f32 v[32:33], v[32:33], v[128:129]
    v_pk_mul_f32 v[34:35], v[34:35], v[130:131]
    v_cvt_pk_bf16_f32 v136, v28, v29
    v_cvt_pk_bf16_f32 v137, v30, v31
    v_cvt_pk_bf16_f32 v138, v32, v33
    v_cvt_pk_bf16_f32 v139, v34, v35
    buffer_store_dwordx4 v[136:139], v2, s[4:7], s24 offen offset:1024 sc1
    v_pk_mul_f32 v[116:117], v[36:37], v[36:37]
    v_pk_mul_f32 v[118:119], v[38:39], v[38:39]
    v_pk_mul_f32 v[120:121], v[40:41], v[40:41]
    v_pk_mul_f32 v[122:123], v[42:43], v[42:43]
    v_pk_fma_f32 v[116:117], v[116:117], v[104:105], v[102:103]
    v_pk_fma_f32 v[118:119], v[118:119], v[104:105], v[102:103]
    v_pk_fma_f32 v[120:121], v[120:121], v[104:105], v[102:103]
    v_pk_fma_f32 v[122:123], v[122:123], v[104:105], v[102:103]
    v_pk_mul_f32 v[116:117], v[116:117], v[36:37]
    v_pk_mul_f32 v[118:119], v[118:119], v[38:39]
    v_pk_mul_f32 v[120:121], v[120:121], v[40:41]
    v_pk_mul_f32 v[122:123], v[122:123], v[42:43]
    v_exp_f32 v116, v116
    v_exp_f32 v117, v117
    v_exp_f32 v118, v118
    v_exp_f32 v119, v119
    v_exp_f32 v120, v120
    v_exp_f32 v121, v121
    v_exp_f32 v122, v122
    v_exp_f32 v123, v123
    v_pk_fma_f32 v[116:117], v[116:117], v[106:107], v[106:107]
    v_pk_fma_f32 v[118:119], v[118:119], v[106:107], v[106:107]
    v_pk_fma_f32 v[120:121], v[120:121], v[106:107], v[106:107]
    v_pk_fma_f32 v[122:123], v[122:123], v[106:107], v[106:107]
    v_rcp_f32 v116, v116
    v_rcp_f32 v117, v117
    v_rcp_f32 v118, v118
    v_rcp_f32 v119, v119
    v_rcp_f32 v120, v120
    v_rcp_f32 v121, v121
    v_rcp_f32 v122, v122
    v_rcp_f32 v123, v123
    v_pk_mul_f32 v[36:37], v[36:37], v[116:117]
    v_pk_mul_f32 v[38:39], v[38:39], v[118:119]
    v_pk_mul_f32 v[40:41], v[40:41], v[120:121]
    v_pk_mul_f32 v[42:43], v[42:43], v[122:123]
    v_cvt_pk_bf16_f32 v132, v36, v37
    v_cvt_pk_bf16_f32 v133, v38, v39
    v_cvt_pk_bf16_f32 v134, v40, v41
    v_cvt_pk_bf16_f32 v135, v42, v43
    buffer_store_dwordx4 v[132:135], v2, s[4:7], s24 offen offset:2048 sc1
    v_pk_mul_f32 v[124:125], v[44:45], v[44:45]
    v_pk_mul_f32 v[126:127], v[46:47], v[46:47]
    v_pk_mul_f32 v[128:129], v[48:49], v[48:49]
    v_pk_mul_f32 v[130:131], v[50:51], v[50:51]
    v_pk_fma_f32 v[124:125], v[124:125], v[104:105], v[102:103]
    v_pk_fma_f32 v[126:127], v[126:127], v[104:105], v[102:103]
    v_pk_fma_f32 v[128:129], v[128:129], v[104:105], v[102:103]
    v_pk_fma_f32 v[130:131], v[130:131], v[104:105], v[102:103]
    v_pk_mul_f32 v[124:125], v[124:125], v[44:45]
    v_pk_mul_f32 v[126:127], v[126:127], v[46:47]
    v_pk_mul_f32 v[128:129], v[128:129], v[48:49]
    v_pk_mul_f32 v[130:131], v[130:131], v[50:51]
    v_exp_f32 v124, v124
    v_exp_f32 v125, v125
    v_exp_f32 v126, v126
    v_exp_f32 v127, v127
    v_exp_f32 v128, v128
    v_exp_f32 v129, v129
    v_exp_f32 v130, v130
    v_exp_f32 v131, v131
    v_pk_fma_f32 v[124:125], v[124:125], v[106:107], v[106:107]
    v_pk_fma_f32 v[126:127], v[126:127], v[106:107], v[106:107]
    v_pk_fma_f32 v[128:129], v[128:129], v[106:107], v[106:107]
    v_pk_fma_f32 v[130:131], v[130:131], v[106:107], v[106:107]
    v_rcp_f32 v124, v124
    v_rcp_f32 v125, v125
    v_rcp_f32 v126, v126
    v_rcp_f32 v127, v127
    v_rcp_f32 v128, v128
    v_rcp_f32 v129, v129
    v_rcp_f32 v130, v130
    v_rcp_f32 v131, v131
    v_pk_mul_f32 v[44:45], v[44:45], v[124:125]
    v_pk_mul_f32 v[46:47], v[46:47], v[126:127]
    v_pk_mul_f32 v[48:49], v[48:49], v[128:129]
    v_pk_mul_f32 v[50:51], v[50:51], v[130:131]
    v_cvt_pk_bf16_f32 v136, v44, v45
    v_cvt_pk_bf16_f32 v137, v46, v47
    v_cvt_pk_bf16_f32 v138, v48, v49
    v_cvt_pk_bf16_f32 v139, v50, v51
    buffer_store_dwordx4 v[136:139], v2, s[4:7], s24 offen offset:3072 sc1
    s_cmp_eq_u32 s22, 13
    s_cbranch_scc1 L_p4_sigA
    s_add_u32 s24, s24, 57344
    v_pk_mul_f32 v[116:117], v[52:53], v[52:53]
    v_pk_mul_f32 v[118:119], v[54:55], v[54:55]
    v_pk_mul_f32 v[120:121], v[56:57], v[56:57]
    v_pk_mul_f32 v[122:123], v[58:59], v[58:59]
    v_pk_fma_f32 v[116:117], v[116:117], v[104:105], v[102:103]
    v_pk_fma_f32 v[118:119], v[118:119], v[104:105], v[102:103]
    v_pk_fma_f32 v[120:121], v[120:121], v[104:105], v[102:103]
    v_pk_fma_f32 v[122:123], v[122:123], v[104:105], v[102:103]
    v_pk_mul_f32 v[116:117], v[116:117], v[52:53]
    v_pk_mul_f32 v[118:119], v[118:119], v[54:55]
    v_pk_mul_f32 v[120:121], v[120:121], v[56:57]
    v_pk_mul_f32 v[122:123], v[122:123], v[58:59]
    v_exp_f32 v116, v116
    v_exp_f32 v117, v117
    v_exp_f32 v118, v118
    v_exp_f32 v119, v119
    v_exp_f32 v120, v120
    v_exp_f32 v121, v121
    v_exp_f32 v122, v122
    v_exp_f32 v123, v123
    v_pk_fma_f32 v[116:117], v[116:117], v[106:107], v[106:107]
    v_pk_fma_f32 v[118:119], v[118:119], v[106:107], v[106:107]
    v_pk_fma_f32 v[120:121], v[120:121], v[106:107], v[106:107]
    v_pk_fma_f32 v[122:123], v[122:123], v[106:107], v[106:107]
    v_rcp_f32 v116, v116
    v_rcp_f32 v117, v117
    v_rcp_f32 v118, v118
    v_rcp_f32 v119, v119
    v_rcp_f32 v120, v120
    v_rcp_f32 v121, v121
    v_rcp_f32 v122, v122
    v_rcp_f32 v123, v123
    v_pk_mul_f32 v[52:53], v[52:53], v[116:117]
    v_pk_mul_f32 v[54:55], v[54:55], v[118:119]
    v_pk_mul_f32 v[56:57], v[56:57], v[120:121]
    v_pk_mul_f32 v[58:59], v[58:59], v[122:123]
    v_cvt_pk_bf16_f32 v132, v52, v53
    v_cvt_pk_bf16_f32 v133, v54, v55
    v_cvt_pk_bf16_f32 v134, v56, v57
    v_cvt_pk_bf16_f32 v135, v58, v59
    buffer_store_dwordx4 v[132:135], v2, s[4:7], s24 offen offset:0 sc1
    v_pk_mul_f32 v[124:125], v[60:61], v[60:61]
    v_pk_mul_f32 v[126:127], v[62:63], v[62:63]
    v_pk_mul_f32 v[128:129], v[64:65], v[64:65]
    v_pk_mul_f32 v[130:131], v[66:67], v[66:67]
    v_pk_fma_f32 v[124:125], v[124:125], v[104:105], v[102:103]
    v_pk_fma_f32 v[126:127], v[126:127], v[104:105], v[102:103]
    v_pk_fma_f32 v[128:129], v[128:129], v[104:105], v[102:103]
    v_pk_fma_f32 v[130:131], v[130:131], v[104:105], v[102:103]
    v_pk_mul_f32 v[124:125], v[124:125], v[60:61]
    v_pk_mul_f32 v[126:127], v[126:127], v[62:63]
    v_pk_mul_f32 v[128:129], v[128:129], v[64:65]
    v_pk_mul_f32 v[130:131], v[130:131], v[66:67]
    v_exp_f32 v124, v124
    v_exp_f32 v125, v125
    v_exp_f32 v126, v126
    v_exp_f32 v127, v127
    v_exp_f32 v128, v128
    v_exp_f32 v129, v129
    v_exp_f32 v130, v130
    v_exp_f32 v131, v131
    v_pk_fma_f32 v[124:125], v[124:125], v[106:107], v[106:107]
    v_pk_fma_f32 v[126:127], v[126:127], v[106:107], v[106:107]
    v_pk_fma_f32 v[128:129], v[128:129], v[106:107], v[106:107]
    v_pk_fma_f32 v[130:131], v[130:131], v[106:107], v[106:107]
    v_rcp_f32 v124, v124
    v_rcp_f32 v125, v125
    v_rcp_f32 v126, v126
    v_rcp_f32 v127, v127
    v_rcp_f32 v128, v128
    v_rcp_f32 v129, v129
    v_rcp_f32 v130, v130
    v_rcp_f32 v131, v131
    v_pk_mul_f32 v[60:61], v[60:61], v[124:125]
    v_pk_mul_f32 v[62:63], v[62:63], v[126:127]
    v_pk_mul_f32 v[64:65], v[64:65], v[128:129]
    v_pk_mul_f32 v[66:67], v[66:67], v[130:131]
    v_cvt_pk_bf16_f32 v136, v60, v61
    v_cvt_pk_bf16_f32 v137, v62, v63
    v_cvt_pk_bf16_f32 v138, v64, v65
    v_cvt_pk_bf16_f32 v139, v66, v67
    s_waitcnt vmcnt(1)
    v_mov_b32 v140, 163792
    v_mov_b32 v141, 1
    s_mov_b64 exec, 1
    ds_add_rtn_u32 v142, v140, v141
    s_waitcnt lgkmcnt(0)
    v_readfirstlane_b32 s74, v142
    s_cmp_lg_u32 s74, 3
    s_cbranch_scc1 L_p4a_nosig
    s_mov_b64 exec, 0xff
    s_lshl_b32 s74, s68, 7
    s_add_u32 s74, s74, 262144
    v_mov_b32 v140, s76
    v_mov_b32 v141, s77
    v_mov_b32 v142, 0
    v_mov_b32 v143, 0
    buffer_store_dwordx4 v[140:143], v2, s[4:7], s74 offen sc1
L_p4a_nosig:
    s_mov_b64 exec, -1
    buffer_store_dwordx4 v[136:139], v2, s[4:7], s24 offen offset:1024 sc1
    v_pk_mul_f32 v[116:117], v[68:69], v[68:69]
    v_pk_mul_f32 v[118:119], v[70:71], v[70:71]
    v_pk_mul_f32 v[120:121], v[72:73], v[72:73]
    v_pk_mul_f32 v[122:123], v[74:75], v[74:75]
    v_pk_fma_f32 v[116:117], v[116:117], v[104:105], v[102:103]
    v_pk_fma_f32 v[118:119], v[118:119], v[104:105], v[102:103]
    v_pk_fma_f32 v[120:121], v[120:121], v[104:105], v[102:103]
    v_pk_fma_f32 v[122:123], v[122:123], v[104:105], v[102:103]
    v_pk_mul_f32 v[116:117], v[116:117], v[68:69]
    v_pk_mul_f32 v[118:119], v[118:119], v[70:71]
    v_pk_mul_f32 v[120:121], v[120:121], v[72:73]
    v_pk_mul_f32 v[122:123], v[122:123], v[74:75]
    v_exp_f32 v116, v116
    v_exp_f32 v117, v117
    v_exp_f32 v118, v118
    v_exp_f32 v119, v119
    v_exp_f32 v120, v120
    v_exp_f32 v121, v121
    v_exp_f32 v122, v122
    v_exp_f32 v123, v123
    v_pk_fma_f32 v[116:117], v[116:117], v[106:107], v[106:107]
    v_pk_fma_f32 v[118:119], v[118:119], v[106:107], v[106:107]
    v_pk_fma_f32 v[120:121], v[120:121], v[106:107], v[106:107]
    v_pk_fma_f32 v[122:123], v[122:123], v[106:107], v[106:107]
    v_rcp_f32 v116, v116
    v_rcp_f32 v117, v117
    v_rcp_f32 v118, v118
    v_rcp_f32 v119, v119
    v_rcp_f32 v120, v120
    v_rcp_f32 v121, v121
    v_rcp_f32 v122, v122
    v_rcp_f32 v123, v123
    v_pk_mul_f32 v[68:69], v[68:69], v[116:117]
    v_pk_mul_f32 v[70:71], v[70:71], v[118:119]
    v_pk_mul_f32 v[72:73], v[72:73], v[120:121]
    v_pk_mul_f32 v[74:75], v[74:75], v[122:123]
    v_cvt_pk_bf16_f32 v132, v68, v69
    v_cvt_pk_bf16_f32 v133, v70, v71
    v_cvt_pk_bf16_f32 v134, v72, v73
    v_cvt_pk_bf16_f32 v135, v74, v75
    buffer_store_dwordx4 v[132:135], v2, s[4:7], s24 offen offset:2048 sc1
    v_pk_mul_f32 v[124:125], v[76:77], v[76:77]
    v_pk_mul_f32 v[126:127], v[78:79], v[78:79]
    v_pk_mul_f32 v[128:129], v[80:81], v[80:81]
    v_pk_mul_f32 v[130:131], v[82:83], v[82:83]
    v_pk_fma_f32 v[124:125], v[124:125], v[104:105], v[102:103]
    v_pk_fma_f32 v[126:127], v[126:127], v[104:105], v[102:103]
    v_pk_fma_f32 v[128:129], v[128:129], v[104:105], v[102:103]
    v_pk_fma_f32 v[130:131], v[130:131], v[104:105], v[102:103]
    v_pk_mul_f32 v[124:125], v[124:125], v[76:77]
    v_pk_mul_f32 v[126:127], v[126:127], v[78:79]
    v_pk_mul_f32 v[128:129], v[128:129], v[80:81]
    v_pk_mul_f32 v[130:131], v[130:131], v[82:83]
    v_exp_f32 v124, v124
    v_exp_f32 v125, v125
    v_exp_f32 v126, v126
    v_exp_f32 v127, v127
    v_exp_f32 v128, v128
    v_exp_f32 v129, v129
    v_exp_f32 v130, v130
    v_exp_f32 v131, v131
    v_pk_fma_f32 v[124:125], v[124:125], v[106:107], v[106:107]
    v_pk_fma_f32 v[126:127], v[126:127], v[106:107], v[106:107]
    v_pk_fma_f32 v[128:129], v[128:129], v[106:107], v[106:107]
    v_pk_fma_f32 v[130:131], v[130:131], v[106:107], v[106:107]
    v_rcp_f32 v124, v124
    v_rcp_f32 v125, v125
    v_rcp_f32 v126, v126
    v_rcp_f32 v127, v127
    v_rcp_f32 v128, v128
    v_rcp_f32 v129, v129
    v_rcp_f32 v130, v130
    v_rcp_f32 v131, v131
    v_pk_mul_f32 v[76:77], v[76:77], v[124:125]
    v_pk_mul_f32 v[78:79], v[78:79], v[126:127]
    v_pk_mul_f32 v[80:81], v[80:81], v[128:129]
    v_pk_mul_f32 v[82:83], v[82:83], v[130:131]
    v_cvt_pk_bf16_f32 v136, v76, v77
    v_cvt_pk_bf16_f32 v137, v78, v79
    v_cvt_pk_bf16_f32 v138, v80, v81
    v_cvt_pk_bf16_f32 v139, v82, v83
    buffer_store_dwordx4 v[136:139], v2, s[4:7], s24 offen offset:3072 sc1
    s_add_u32 s68, s68, 384
    v_mov_b32 v140, 163796
    v_mov_b32 v141, 1
    s_mov_b64 exec, 1
    s_waitcnt vmcnt(0)
    ds_add_rtn_u32 v142, v140, v141
    s_waitcnt lgkmcnt(0)
    v_readfirstlane_b32 s74, v142
    s_cmp_lg_u32 s74, 3
    s_cbranch_scc1 L_p4b_nosig
    s_mov_b64 exec, 0xff
    s_lshl_b32 s74, s68, 7
    s_add_u32 s74, s74, 262144
    v_mov_b32 v140, s76
    v_mov_b32 v141, s77
    v_mov_b32 v142, 0
    v_mov_b32 v143, 0
    buffer_store_dwordx4 v[140:143], v2, s[4:7], s74 offen sc1
L_p4b_nosig:
    s_mov_b64 exec, -1
    s_branch L_p4_fin
L_p4_sigA:
    v_mov_b32 v140, 163792
    v_mov_b32 v141, 1
    s_mov_b64 exec, 1
    s_waitcnt vmcnt(0)
    ds_add_rtn_u32 v142, v140, v141
    s_waitcnt lgkmcnt(0)
    v_readfirstlane_b32 s74, v142
    s_cmp_lg_u32 s74, 3
    s_cbranch_scc1 L_p4c_nosig
    s_mov_b64 exec, 0xff
    s_lshl_b32 s74, s68, 7
    s_add_u32 s74, s74, 262144
    v_mov_b32 v140, s76
    v_mov_b32 v141, s77
    v_mov_b32 v142, 0
    v_mov_b32 v143, 0
    buffer_store_dwordx4 v[140:143], v2, s[4:7], s74 offen sc1
L_p4c_nosig:
    s_mov_b64 exec, -1
L_p4_fin:
L_p4_done:
    s_cmp_ge_u32 s67, 28
    s_cbranch_scc1 L_p5_done
    s_lshr_b32 s22, s66, 1
    s_mul_i32 s22, s22, 28
    s_add_u32 s22, s22, s67
    s_cmp_ge_u32 s22, 110
    s_cbranch_scc1 L_p5_done
    s_mul_i32 s21, s22, 205
    s_lshr_b32 s21, s21, 10
    s_mul_i32 s33, s21, 5
    s_sub_u32 s22, s22, s33
    s_and_b32 s20, s66, 1
    s_mul_i32 s20, s20, 5
    s_add_u32 s22, s22, s20
    s_mul_i32 s20, s21, 10
    s_add_u32 s20, s20, s22
    s_mul_i32 s33, s21, 3
    s_cmp_lt_u32 s3, 3
    s_cbranch_scc1 L_p5_compute
    s_cmp_eq_u32 s3, 6
    s_cbranch_scc1 L_p5_wload
    s_lshr_b32 s28, s33, 2
    s_mul_i32 s28, s28, 14
    s_add_u32 s29, s33, 2
    s_min_u32 s29, s29, 63
    s_lshr_b32 s29, s29, 2
    s_mul_i32 s29, s29, 14
    s_add_u32 s29, s29, 13
    v_add_u32 v8, s28, v1
    v_min_u32 v8, s29, v8
    v_mov_b32 v14, 163800
    s_cmp_eq_u32 s3, 3
    s_cbranch_scc1 L_p5_w3
    s_mul_i32 s12, s33, 110592
    s_sub_u32 s14, 7077888, s12
    s_min_u32 s14, s14, 331776
    s_add_u32 s12, s12, 15204352
    s_add_u32 s12, s64, s12
    s_addc_u32 s13, s65, 0
    s_mov_b32 s15, 0x20000
    s_cmp_lg_u32 s3, 7
    s_cbranch_scc1 L_p5_t45
    v_add_u32 v8, 896, v8
    v_mov_b32 v9, 5
    v_cmp_gt_u32 vcc, 32, v1
    v_lshlrev_b32 v13, 2, v1
    s_lshl_b32 s34, s22, 8
    v_cndmask_b32 v8, v9, v8, vcc
    v_lshlrev_b32 v8, 7, v8
    s_mov_b32 s74, 0
    s_mov_b32 s75, 262144
L_p5_poll:
    buffer_load_dwordx2 v[10:11], v8, s[4:7], s75 offen sc1
    s_add_u32 s74, s74, 1
    s_waitcnt vmcnt(0)
    v_cmp_ne_u64 vcc, s[76:77], v[10:11]
    s_cmp_gt_u32 s74, 400000
    s_cbranch_scc1 L_p5_go
    s_nop 2
    s_cbranch_vccz L_p5_go
    s_sleep 1
    s_branch L_p5_poll
L_p5_go:
    v_mov_b32 v15, 1
    ds_write_b32 v14, v15
    s_add_u32 s35, s34, 12800
    s_mov_b32 m0, 160768
    s_nop 0
    buffer_load_dword v13, s[4:7], s35 offen sc1 lds
    s_mov_b32 s25, 0
    s_mov_b32 s26, 81920
    s_mov_b32 s28, 0
    s_mov_b32 s24, 4
    s_mov_b32 s23, 0
L_p5c_ti:
    s_add_u32 m0, s26, 0
    s_add_u32 s27, s25, 0
    buffer_load_dwordx4 v2, s[12:15], s27 offen sc1 lds
    s_add_u32 m0, s26, 1024
    s_add_u32 s27, s25, 1024
    buffer_load_dwordx4 v2, s[12:15], s27 offen sc1 lds
    s_add_u32 m0, s26, 2048
    s_add_u32 s27, s25, 2048
    buffer_load_dwordx4 v2, s[12:15], s27 offen sc1 lds
    s_add_u32 m0, s26, 3072
    s_add_u32 s27, s25, 3072
    buffer_load_dwordx4 v2, s[12:15], s27 offen sc1 lds
    s_add_u32 s25, s25, 4096
    s_add_u32 s26, s26, 12288
    s_cmp_eq_u32 s26, 143360
    s_cselect_b32 s26, 81920, s26
    s_add_u32 s28, s28, 1
    s_cmp_lt_u32 s28, s24
    s_cbranch_scc1 L_p5c_ti
    s_cmp_ge_u32 s28, 27
    s_cbranch_scc1 L_p5c_tt
    s_waitcnt vmcnt(12)
    s_barrier
    s_add_u32 s24, s24, 1
    s_branch L_p5c_ti
L_p5c_tt:
    s_waitcnt vmcnt(12)
    s_barrier
    s_waitcnt vmcnt(8)
    s_barrier
    s_waitcnt vmcnt(4)
    s_barrier
    s_waitcnt vmcnt(0)
    s_barrier
    s_barrier
    s_branch L_p5_done
L_p5_t45:
    ds_read_b32 v15, v14
    s_waitcnt lgkmcnt(0)
    v_readfirstlane_b32 s28, v15
    s_cmp_eq_u32 s28, 1
    s_cbranch_scc1 L_p5_tgo
    s_sleep 1
    s_branch L_p5_t45
L_p5_tgo:
    s_cmp_eq_u32 s3, 4
    s_cbranch_scc1 L_p5_t4
    s_mov_b32 s25, 0
    s_mov_b32 s26, 81920
    s_mov_b32 s28, 0
    s_mov_b32 s24, 4
    s_mov_b32 s23, 0
L_p5b_ti:
    s_add_u32 m0, s26, 4096
    s_add_u32 s27, s25, 110592
    buffer_load_dwordx4 v2, s[12:15], s27 offen sc1 lds
    s_add_u32 m0, s26, 5120
    s_add_u32 s27, s25, 111616
    buffer_load_dwordx4 v2, s[12:15], s27 offen sc1 lds
    s_add_u32 m0, s26, 6144
    s_add_u32 s27, s25, 112640
    buffer_load_dwordx4 v2, s[12:15], s27 offen sc1 lds
    s_add_u32 m0, s26, 7168
    s_add_u32 s27, s25, 113664
    buffer_load_dwordx4 v2, s[12:15], s27 offen sc1 lds
    s_add_u32 s25, s25, 4096
    s_add_u32 s26, s26, 12288
    s_cmp_eq_u32 s26, 143360
    s_cselect_b32 s26, 81920, s26
    s_add_u32 s28, s28, 1
    s_cmp_lt_u32 s28, s24
    s_cbranch_scc1 L_p5b_ti
    s_cmp_ge_u32 s28, 27
    s_cbranch_scc1 L_p5b_tt
    s_waitcnt vmcnt(12)
    s_barrier
    s_add_u32 s24, s24, 1
    s_branch L_p5b_ti
L_p5b_tt:
    s_waitcnt vmcnt(12)
    s_barrier
    s_waitcnt vmcnt(8)
    s_barrier
    s_waitcnt vmcnt(4)
    s_barrier
    s_waitcnt vmcnt(0)
    s_barrier
    s_barrier
    s_branch L_p5_done
L_p5_t4:
    s_mov_b32 s25, 0
    s_mov_b32 s26, 81920
    s_mov_b32 s28, 0
    s_mov_b32 s24, 4
    s_mov_b32 s23, 0
L_p5a_ti:
    s_add_u32 m0, s26, 8192
    s_add_u32 s27, s25, 221184
    buffer_load_dwordx4 v2, s[12:15], s27 offen sc1 lds
    s_add_u32 m0, s26, 9216
    s_add_u32 s27, s25, 222208
    buffer_load_dwordx4 v2, s[12:15], s27 offen sc1 lds
    s_add_u32 m0, s26, 10240
    s_add_u32 s27, s25, 223232
    buffer_load_dwordx4 v2, s[12:15], s27 offen sc1 lds
    s_add_u32 m0, s26, 11264
    s_add_u32 s27, s25, 224256
    buffer_load_dwordx4 v2, s[12:15], s27 offen sc1 lds
    s_add_u32 s25, s25, 4096
    s_add_u32 s26, s26, 12288
    s_cmp_eq_u32 s26, 143360
    s_cselect_b32 s26, 81920, s26
    s_add_u32 s28, s28, 1
    s_cmp_lt_u32 s28, s24
    s_cbranch_scc1 L_p5a_ti
    s_cmp_ge_u32 s28, 27
    s_cbranch_scc1 L_p5a_tt
    s_waitcnt vmcnt(12)
    s_barrier
    s_add_u32 s24, s24, 1
    s_branch L_p5a_ti
L_p5a_tt:
    s_waitcnt vmcnt(12)
    s_barrier
    s_waitcnt vmcnt(8)
    s_barrier
    s_waitcnt vmcnt(4)
    s_barrier
    s_waitcnt vmcnt(0)
    s_barrier
    s_barrier
    s_branch L_p5_done
L_p5_w3:
    v_mul_u32_u24 v9, 4682, v8
    v_lshrrev_b32 v9, 16, v9
    v_mul_u32_u24 v9, 14, v9
    v_sub_u32 v9, v8, v9
    v_mov_b32 v10, 1280
    v_mov_b32 v11, 896
    v_cmp_eq_u32 vcc, 13, v9
    s_mov_b32 s75, 262144
    s_nop 0
    v_cndmask_b32 v10, v10, v11, vcc
    v_add_u32 v8, v8, v10
    v_lshlrev_b32 v12, 7, v8
    s_barrier
    s_barrier
    s_barrier
    buffer_load_dwordx2 v[10:11], v12, s[4:7], s75 offen sc1
    s_barrier
    s_barrier
    s_barrier
    s_waitcnt vmcnt(0)
    v_cmp_ne_u64 vcc, s[76:77], v[10:11]
    s_nop 4
    s_cbranch_vccz L_p5w3_go
    v_lshlrev_b32 v8, 7, v8
    s_mov_b32 s74, 0
    s_mov_b32 s75, 262144
L_p5w3_poll:
    buffer_load_dwordx2 v[10:11], v8, s[4:7], s75 offen sc1
    s_add_u32 s74, s74, 1
    s_waitcnt vmcnt(0)
    v_cmp_ne_u64 vcc, s[76:77], v[10:11]
    s_cmp_gt_u32 s74, 400000
    s_cbranch_scc1 L_p5w3_go
    s_nop 2
    s_cbranch_vccz L_p5w3_go
    s_sleep 1
    s_branch L_p5w3_poll
L_p5w3_go:
    s_mov_b32 s28, 0
L_p5i_idle:
    s_barrier
    s_add_u32 s28, s28, 1
    s_cmp_lt_u32 s28, 22
    s_cbranch_scc1 L_p5i_idle
    s_branch L_p5_done
L_p5_wload:
    s_mov_b32 s8, s52
    s_mov_b32 s9, s53
    s_mov_b32 s10, 2211840
    s_mov_b32 s11, 0x20000
    s_mov_b32 s12, s54
    s_mov_b32 s13, s55
    s_mov_b32 s14, 1280
    s_mov_b32 s15, 0x20000
    v_lshlrev_b32 v13, 2, v1
    s_lshl_b32 s34, s22, 7
    s_mov_b32 m0, 161024
    s_nop 0
    buffer_load_dword v13, s[12:15], s34 offen lds
    s_mov_b32 s24, 1280
    s_mov_b32 s73, 0
    v_lshrrev_b32 v9, 3, v1
    v_bfe_u32 v10, v1, 4, 1
    v_lshlrev_b32 v10, 2, v10
    v_and_b32 v8, 7, v1
    v_xor_b32 v8, v8, v10
    v_lshlrev_b32 v8, 4, v8
    v_mad_u32_u24 v8, v9, s24, v8
    v_add_u32 v8, s34, v8
    s_mov_b32 s29, 10240
    s_sub_u32 s25, 0, s29
    s_mov_b32 s26, 0
    s_mov_b32 s28, 0
L_p5_wfill:
    s_mov_b32 m0, s26
    s_add_u32 s25, s25, s29
    buffer_load_dwordx4 v8, s[8:11], s25 offen lds
    s_add_u32 m0, s26, 1024
    s_add_u32 s25, s25, s29
    buffer_load_dwordx4 v8, s[8:11], s25 offen lds
    s_add_u32 m0, s26, 2048
    s_add_u32 s25, s25, s29
    buffer_load_dwordx4 v8, s[8:11], s25 offen lds
    s_add_u32 m0, s26, 3072
    s_add_u32 s25, s25, s29
    buffer_load_dwordx4 v8, s[8:11], s25 offen lds
    s_add_u32 m0, s26, 4096
    s_add_u32 s25, s25, s29
    buffer_load_dwordx4 v8, s[8:11], s25 offen lds
    s_add_u32 m0, s26, 5120
    s_add_u32 s25, s25, s29
    buffer_load_dwordx4 v8, s[8:11], s25 offen lds
    s_add_u32 m0, s26, 6144
    s_add_u32 s25, s25, s29
    buffer_load_dwordx4 v8, s[8:11], s25 offen lds
    s_add_u32 m0, s26, 7168
    s_add_u32 s25, s25, s29
    buffer_load_dwordx4 v8, s[8:11], s25 offen lds
    s_add_u32 s25, s25, 81920
    s_add_u32 s73, s73, 1
    s_cmp_eq_u32 s73, 14
    s_cselect_b32 s25, 71680, s25
    s_add_u32 s26, s26, 8192
    s_cmp_eq_u32 s26, 81920
    s_cselect_b32 s26, 0, s26
    s_add_u32 s28, s28, 1
    s_cmp_lt_u32 s28, 10
    s_cbranch_scc1 L_p5_wfill
    s_waitcnt vmcnt(63)
    s_barrier
    s_mov_b32 s28, 0
L_p5_wloop:
    s_waitcnt vmcnt(63)
    s_barrier
    s_mov_b32 m0, s26
    s_add_u32 s25, s25, s29
    buffer_load_dwordx4 v8, s[8:11], s25 offen lds
    s_add_u32 m0, s26, 1024
    s_add_u32 s25, s25, s29
    buffer_load_dwordx4 v8, s[8:11], s25 offen lds
    s_add_u32 m0, s26, 2048
    s_add_u32 s25, s25, s29
    buffer_load_dwordx4 v8, s[8:11], s25 offen lds
    s_add_u32 m0, s26, 3072
    s_add_u32 s25, s25, s29
    buffer_load_dwordx4 v8, s[8:11], s25 offen lds
    s_add_u32 m0, s26, 4096
    s_add_u32 s25, s25, s29
    buffer_load_dwordx4 v8, s[8:11], s25 offen lds
    s_add_u32 m0, s26, 5120
    s_add_u32 s25, s25, s29
    buffer_load_dwordx4 v8, s[8:11], s25 offen lds
    s_add_u32 m0, s26, 6144
    s_add_u32 s25, s25, s29
    buffer_load_dwordx4 v8, s[8:11], s25 offen lds
    s_add_u32 m0, s26, 7168
    s_add_u32 s25, s25, s29
    buffer_load_dwordx4 v8, s[8:11], s25 offen lds
    s_add_u32 s25, s25, 81920
    s_add_u32 s73, s73, 1
    s_cmp_eq_u32 s73, 14
    s_cselect_b32 s25, 71680, s25
    s_add_u32 s26, s26, 8192
    s_cmp_eq_u32 s26, 81920
    s_cselect_b32 s26, 0, s26
    s_add_u32 s28, s28, 1
    s_cmp_lt_u32 s28, 17
    s_cbranch_scc1 L_p5_wloop
    s_waitcnt vmcnt(63)
    s_barrier
    s_waitcnt vmcnt(56)
    s_barrier
    s_waitcnt vmcnt(48)
    s_barrier
    s_waitcnt vmcnt(40)
    s_barrier
    s_waitcnt vmcnt(32)
    s_barrier
    s_waitcnt vmcnt(24)
    s_barrier
    s_waitcnt vmcnt(16)
    s_barrier
    s_waitcnt vmcnt(8)
    s_barrier
    s_waitcnt vmcnt(0)
    s_barrier
    s_barrier
    s_branch L_p5_done
L_p5_compute:
    s_mov_b32 s16, s60
    s_mov_b32 s17, s61
    s_mov_b32 s18, 2621440
    s_mov_b32 s19, 0x20000
    s_add_u32 s23, s33, s3
    s_min_u32 s24, s23, 63
    s_mul_i32 s24, s24, 40
    s_lshl_b32 s25, s22, 2
    s_add_u32 s24, s24, s25
    s_lshl_b32 s24, s24, 10
    s_add_u32 s24, s24, 9961472
    buffer_load_dwordx4 v[192:195], v2, s[4:7], s24 offen sc1
    buffer_load_dwordx4 v[196:199], v2, s[4:7], s24 offen offset:1024 sc1
    buffer_load_dwordx4 v[200:203], v2, s[4:7], s24 offen offset:2048 sc1
    buffer_load_dwordx4 v[204:207], v2, s[4:7], s24 offen offset:3072 sc1
    v_bfe_u32 v14, v1, 2, 2
    v_lshl_add_u32 v15, v4, 3, v14
    v_mul_u32_u24 v8, 128, v15
    v_lshrrev_b32 v14, 1, v14
    v_xor_b32 v14, 0, v14
    v_lshl_add_u32 v8, v14, 6, v8
    v_bfe_u32 v14, v1, 4, 1
    v_lshl_add_u32 v8, v14, 5, v8
    v_and_b32 v14, 1, v1
    v_lshl_add_u32 v8, v14, 4, v8
    v_bfe_u32 v14, v1, 1, 1
    v_lshl_add_u32 v8, v14, 3, v8
    v_bfe_u32 v14, v1, 2, 2
    v_lshl_add_u32 v15, v4, 3, v14
    v_mul_u32_u24 v9, 128, v15
    v_lshrrev_b32 v14, 1, v14
    v_xor_b32 v14, 1, v14
    v_lshl_add_u32 v9, v14, 6, v9
    v_bfe_u32 v14, v1, 4, 1
    v_lshl_add_u32 v9, v14, 5, v9
    v_and_b32 v14, 1, v1
    v_lshl_add_u32 v9, v14, 4, v9
    v_bfe_u32 v14, v1, 1, 1
    v_lshl_add_u32 v9, v14, 3, v9
    s_mul_i32 s30, s3, 4096
    v_add_u32 v12, s30, v2
    v_mov_b32 v16, 0
    v_mov_b32 v17, 0
    v_mov_b32 v18, 0
    v_mov_b32 v19, 0
    v_mov_b32 v20, 0
    v_mov_b32 v21, 0
    v_mov_b32 v22, 0
    v_mov_b32 v23, 0
    v_mov_b32 v24, 0
    v_mov_b32 v25, 0
    v_mov_b32 v26, 0
    v_mov_b32 v27, 0
    v_mov_b32 v28, 0
    v_mov_b32 v29, 0
    v_mov_b32 v30, 0
    v_mov_b32 v31, 0
    v_mov_b32 v32, 0
    v_mov_b32 v33, 0
    v_mov_b32 v34, 0
    v_mov_b32 v35, 0
    v_mov_b32 v36, 0
    v_mov_b32 v37, 0
    v_mov_b32 v38, 0
    v_mov_b32 v39, 0
    v_mov_b32 v40, 0
    v_mov_b32 v41, 0
    v_mov_b32 v42, 0
    v_mov_b32 v43, 0
    v_mov_b32 v44, 0
    v_mov_b32 v45, 0
    v_mov_b32 v46, 0
    v_mov_b32 v47, 0
    s_mov_b32 s31, 0
    s_mov_b32 s32, 81920
    v_add_u32 v10, s31, v8
    v_add_u32 v11, s31, v9
    v_add_u32 v13, s32, v12
    s_add_u32 s31, s31, 8192
    s_cmp_eq_u32 s31, 81920
    s_cselect_b32 s31, 0, s31
    s_add_u32 s32, s32, 12288
    s_cmp_eq_u32 s32, 143360
    s_cselect_b32 s32, 81920, s32
    s_barrier
    ds_read_b128 v[48:51], v13 offset:0
    ds_read_b64_tr_b16 v[64:65], v10 offset:0
    ds_read_b64_tr_b16 v[66:67], v10 offset:512
    ds_read_b64_tr_b16 v[68:69], v11 offset:0
    ds_read_b64_tr_b16 v[70:71], v11 offset:512
    ds_read_b128 v[52:55], v13 offset:1024
    ds_read_b64_tr_b16 v[72:73], v10 offset:2048
    ds_read_b64_tr_b16 v[74:75], v10 offset:2560
    ds_read_b64_tr_b16 v[76:77], v11 offset:2048
    ds_read_b64_tr_b16 v[78:79], v11 offset:2560
    s_mov_b32 s28, 0
L_p5_loop:
    s_waitcnt lgkmcnt(5)
    v_mfma_f32_32x32x16_bf16 v[16:31], v[64:67], v[48:51], v[16:31]
    ds_read_b128 v[56:59], v13 offset:2048
    ds_read_b64_tr_b16 v[80:81], v10 offset:4096
    ds_read_b64_tr_b16 v[82:83], v10 offset:4608
    v_mfma_f32_32x32x16_bf16 v[32:47], v[68:71], v[48:51], v[32:47]
    ds_read_b64_tr_b16 v[84:85], v11 offset:4096
    ds_read_b64_tr_b16 v[86:87], v11 offset:4608
    s_waitcnt lgkmcnt(5)
    v_mfma_f32_32x32x16_bf16 v[16:31], v[72:75], v[52:55], v[16:31]
    ds_read_b128 v[60:63], v13 offset:3072
    ds_read_b64_tr_b16 v[88:89], v10 offset:6144
    ds_read_b64_tr_b16 v[90:91], v10 offset:6656
    v_mfma_f32_32x32x16_bf16 v[32:47], v[76:79], v[52:55], v[32:47]
    ds_read_b64_tr_b16 v[92:93], v11 offset:6144
    ds_read_b64_tr_b16 v[94:95], v11 offset:6656
    s_waitcnt lgkmcnt(5)
    v_mfma_f32_32x32x16_bf16 v[16:31], v[80:83], v[56:59], v[16:31]
    s_waitcnt lgkmcnt(0)
    v_add_u32 v10, s31, v8
    v_add_u32 v11, s31, v9
    v_add_u32 v13, s32, v12
    s_add_u32 s31, s31, 8192
    s_cmp_eq_u32 s31, 81920
    s_cselect_b32 s31, 0, s31
    s_add_u32 s32, s32, 12288
    s_cmp_eq_u32 s32, 143360
    s_cselect_b32 s32, 81920, s32
    s_barrier
    v_mfma_f32_32x32x16_bf16 v[32:47], v[84:87], v[56:59], v[32:47]
    ds_read_b128 v[48:51], v13 offset:0
    ds_read_b64_tr_b16 v[64:65], v10 offset:0
    ds_read_b64_tr_b16 v[66:67], v10 offset:512
    ds_read_b64_tr_b16 v[68:69], v11 offset:0
    ds_read_b64_tr_b16 v[70:71], v11 offset:512
    s_waitcnt lgkmcnt(5)
    v_mfma_f32_32x32x16_bf16 v[16:31], v[88:91], v[60:63], v[16:31]
    ds_read_b128 v[52:55], v13 offset:1024
    ds_read_b64_tr_b16 v[72:73], v10 offset:2048
    ds_read_b64_tr_b16 v[74:75], v10 offset:2560
    v_mfma_f32_32x32x16_bf16 v[32:47], v[92:95], v[60:63], v[32:47]
    ds_read_b64_tr_b16 v[76:77], v11 offset:2048
    ds_read_b64_tr_b16 v[78:79], v11 offset:2560
    s_add_u32 s28, s28, 1
    s_cmp_lt_u32 s28, 27
    s_cbranch_scc1 L_p5_loop
    s_waitcnt lgkmcnt(0)
    s_cmp_ge_u32 s23, 64
    s_cbranch_scc1 L_p5_done
    v_lshlrev_b32 v8, 5, v4
    v_add_u32 v8, 160768, v8
    v_lshlrev_b32 v9, 4, v4
    v_add_u32 v9, 161024, v9
    ds_read_b128 v[48:51], v8 offset:0
    ds_read_b128 v[52:55], v8 offset:16
    ds_read_b128 v[56:59], v9 offset:0
    ds_read_b128 v[60:63], v8 offset:64
    ds_read_b128 v[64:67], v8 offset:80
    ds_read_b128 v[68:71], v9 offset:32
    ds_read_b128 v[72:75], v8 offset:128
    ds_read_b128 v[76:79], v8 offset:144
    ds_read_b128 v[80:83], v9 offset:64
    ds_read_b128 v[84:87], v8 offset:192
    ds_read_b128 v[88:91], v8 offset:208
    ds_read_b128 v[92:95], v9 offset:96
    v_mul_u32_u24 v14, 1280, v3
    v_lshl_add_u32 v14, v4, 4, v14
    s_mul_i32 s24, s23, 40960
    s_lshl_b32 s25, s22, 7
    s_add_u32 s24, s24, s25
    s_mov_b32 s26, 0xffff0000
    s_waitcnt vmcnt(0) lgkmcnt(0)
    v_lshlrev_b32 v100, 16, v56
    v_and_b32 v101, s26, v56
    v_lshlrev_b32 v102, 16, v192
    v_and_b32 v103, s26, v192
    v_pk_add_f32 v[100:101], v[100:101], v[16:17]
    v_pk_fma_f32 v[100:101], v[100:101], v[48:49], v[102:103]
    v_cvt_pk_bf16_f32 v112, v100, v101
    v_lshlrev_b32 v104, 16, v57
    v_and_b32 v105, s26, v57
    v_lshlrev_b32 v106, 16, v193
    v_and_b32 v107, s26, v193
    v_pk_add_f32 v[104:105], v[104:105], v[18:19]
    v_pk_fma_f32 v[104:105], v[104:105], v[50:51], v[106:107]
    v_cvt_pk_bf16_f32 v113, v104, v105
    v_lshlrev_b32 v100, 16, v58
    v_and_b32 v101, s26, v58
    v_lshlrev_b32 v102, 16, v194
    v_and_b32 v103, s26, v194
    v_pk_add_f32 v[100:101], v[100:101], v[20:21]
    v_pk_fma_f32 v[100:101], v[100:101], v[52:53], v[102:103]
    v_cvt_pk_bf16_f32 v114, v100, v101
    v_lshlrev_b32 v104, 16, v59
    v_and_b32 v105, s26, v59
    v_lshlrev_b32 v106, 16, v195
    v_and_b32 v107, s26, v195
    v_pk_add_f32 v[104:105], v[104:105], v[22:23]
    v_pk_fma_f32 v[104:105], v[104:105], v[54:55], v[106:107]
    v_cvt_pk_bf16_f32 v115, v104, v105
    buffer_store_dwordx4 v[112:115], v14, s[16:19], s24 offen offset:0
    v_lshlrev_b32 v100, 16, v68
    v_and_b32 v101, s26, v68
    v_lshlrev_b32 v102, 16, v196
    v_and_b32 v103, s26, v196
    v_pk_add_f32 v[100:101], v[100:101], v[24:25]
    v_pk_fma_f32 v[100:101], v[100:101], v[60:61], v[102:103]
    v_cvt_pk_bf16_f32 v116, v100, v101
    v_lshlrev_b32 v104, 16, v69
    v_and_b32 v105, s26, v69
    v_lshlrev_b32 v106, 16, v197
    v_and_b32 v107, s26, v197
    v_pk_add_f32 v[104:105], v[104:105], v[26:27]
    v_pk_fma_f32 v[104:105], v[104:105], v[62:63], v[106:107]
    v_cvt_pk_bf16_f32 v117, v104, v105
    v_lshlrev_b32 v100, 16, v70
    v_and_b32 v101, s26, v70
    v_lshlrev_b32 v102, 16, v198
    v_and_b32 v103, s26, v198
    v_pk_add_f32 v[100:101], v[100:101], v[28:29]
    v_pk_fma_f32 v[100:101], v[100:101], v[64:65], v[102:103]
    v_cvt_pk_bf16_f32 v118, v100, v101
    v_lshlrev_b32 v104, 16, v71
    v_and_b32 v105, s26, v71
    v_lshlrev_b32 v106, 16, v199
    v_and_b32 v107, s26, v199
    v_pk_add_f32 v[104:105], v[104:105], v[30:31]
    v_pk_fma_f32 v[104:105], v[104:105], v[66:67], v[106:107]
    v_cvt_pk_bf16_f32 v119, v104, v105
    buffer_store_dwordx4 v[116:119], v14, s[16:19], s24 offen offset:32
    v_lshlrev_b32 v100, 16, v80
    v_and_b32 v101, s26, v80
    v_lshlrev_b32 v102, 16, v200
    v_and_b32 v103, s26, v200
    v_pk_add_f32 v[100:101], v[100:101], v[32:33]
    v_pk_fma_f32 v[100:101], v[100:101], v[72:73], v[102:103]
    v_cvt_pk_bf16_f32 v120, v100, v101
    v_lshlrev_b32 v104, 16, v81
    v_and_b32 v105, s26, v81
    v_lshlrev_b32 v106, 16, v201
    v_and_b32 v107, s26, v201
    v_pk_add_f32 v[104:105], v[104:105], v[34:35]
    v_pk_fma_f32 v[104:105], v[104:105], v[74:75], v[106:107]
    v_cvt_pk_bf16_f32 v121, v104, v105
    v_lshlrev_b32 v100, 16, v82
    v_and_b32 v101, s26, v82
    v_lshlrev_b32 v102, 16, v202
    v_and_b32 v103, s26, v202
    v_pk_add_f32 v[100:101], v[100:101], v[36:37]
    v_pk_fma_f32 v[100:101], v[100:101], v[76:77], v[102:103]
    v_cvt_pk_bf16_f32 v122, v100, v101
    v_lshlrev_b32 v104, 16, v83
    v_and_b32 v105, s26, v83
    v_lshlrev_b32 v106, 16, v203
    v_and_b32 v107, s26, v203
    v_pk_add_f32 v[104:105], v[104:105], v[38:39]
    v_pk_fma_f32 v[104:105], v[104:105], v[78:79], v[106:107]
    v_cvt_pk_bf16_f32 v123, v104, v105
    buffer_store_dwordx4 v[120:123], v14, s[16:19], s24 offen offset:64
    v_lshlrev_b32 v100, 16, v92
    v_and_b32 v101, s26, v92
    v_lshlrev_b32 v102, 16, v204
    v_and_b32 v103, s26, v204
    v_pk_add_f32 v[100:101], v[100:101], v[40:41]
    v_pk_fma_f32 v[100:101], v[100:101], v[84:85], v[102:103]
    v_cvt_pk_bf16_f32 v124, v100, v101
    v_lshlrev_b32 v104, 16, v93
    v_and_b32 v105, s26, v93
    v_lshlrev_b32 v106, 16, v205
    v_and_b32 v107, s26, v205
    v_pk_add_f32 v[104:105], v[104:105], v[42:43]
    v_pk_fma_f32 v[104:105], v[104:105], v[86:87], v[106:107]
    v_cvt_pk_bf16_f32 v125, v104, v105
    v_lshlrev_b32 v100, 16, v94
    v_and_b32 v101, s26, v94
    v_lshlrev_b32 v102, 16, v206
    v_and_b32 v103, s26, v206
    v_pk_add_f32 v[100:101], v[100:101], v[44:45]
    v_pk_fma_f32 v[100:101], v[100:101], v[88:89], v[102:103]
    v_cvt_pk_bf16_f32 v126, v100, v101
    v_lshlrev_b32 v104, 16, v95
    v_and_b32 v105, s26, v95
    v_lshlrev_b32 v106, 16, v207
    v_and_b32 v107, s26, v207
    v_pk_add_f32 v[104:105], v[104:105], v[46:47]
    v_pk_fma_f32 v[104:105], v[104:105], v[90:91], v[106:107]
    v_cvt_pk_bf16_f32 v127, v104, v105
    buffer_store_dwordx4 v[124:127], v14, s[16:19], s24 offen offset:96
L_p5_done:
L_adaLN_cond__grouped_kv_mqa__mixer_channel_mlp__prompt_kernel_end:
    s_endpgm
L_p2_bar:
    s_cmp_eq_u32 s35, 1
    s_cbranch_scc1 L_p2_bar1
    s_setprio 2
    s_cmp_eq_u32 s35, 2
    s_cbranch_scc1 L_p2_body
    s_setprio 1
    s_cmp_eq_u32 s35, 4
    s_cbranch_scc1 L_p2_body
    s_setprio 0
    s_branch L_p2_body
L_p2_bar1:
    v_mov_b32 v168, 2060
    v_mov_b32 v169, 0
    s_barrier
    ds_write_b32 v168, v169
    ds_write_b32 v168, v169 offset:16
    s_waitcnt lgkmcnt(0)
    s_barrier
    s_branch L_p2_body
L_p2_fallback:
    v_mov_b32 v169, 0xff800000
    s_mul_i32 s34, s23, 81920
    s_add_u32 s34, s34, 87040
    v_subrev_u32 v165, s34, v165
    s_mov_b32 s32, 0
L_p2_fb_tile:
    v_mov_b32 v169, 0xff800000
    s_mov_b32 s70, 0
    v_mov_b32 v24, 0
    v_mov_b32 v25, 0
    v_mov_b32 v26, 0
    v_mov_b32 v27, 0
    v_mov_b32 v28, 0
    v_mov_b32 v29, 0
    v_mov_b32 v30, 0
    v_mov_b32 v31, 0
    v_mov_b32 v32, 0
    v_mov_b32 v33, 0
    v_mov_b32 v34, 0
    v_mov_b32 v35, 0
    v_mov_b32 v36, 0
    v_mov_b32 v37, 0
    v_mov_b32 v38, 0
    v_mov_b32 v39, 0
L_p2_fb_pass:
    v_mov_b32 v56, 0
    v_mov_b32 v57, 0
    v_mov_b32 v58, 0
    v_mov_b32 v59, 0
    v_mov_b32 v60, 0
    v_mov_b32 v61, 0
    v_mov_b32 v62, 0
    v_mov_b32 v63, 0
    v_mov_b32 v64, 0
    v_mov_b32 v65, 0
    v_mov_b32 v66, 0
    v_mov_b32 v67, 0
    v_mov_b32 v68, 0
    v_mov_b32 v69, 0
    v_mov_b32 v70, 0
    v_mov_b32 v71, 0
    s_mov_b32 s71, 589824
    s_mov_b32 s72, 0
L_p2_fb_loop:
    s_add_u32 s73, s71, 4096
    v_lshlrev_b32 v196, 3, v1
    buffer_load_dwordx2 v[144:145], v196, s[4:7], s73 offen sc1
    buffer_load_dwordx2 v[146:147], v196, s[4:7], s73 offen offset:512 sc1
    buffer_load_dwordx4 v[128:131], v2, s[4:7], s71 offen offset:0 sc1
    s_add_u32 s73, s71, 5120
    s_mov_b64 exec, s[68:69]
    buffer_load_dwordx4 v[148:151], v165, s[4:7], s73 offen sc1
    buffer_load_dwordx4 v[152:155], v165, s[4:7], s73 offen offset:640 sc1
    s_mov_b64 exec, -1
    s_waitcnt vmcnt(0)
    v_mfma_f32_32x32x16_bf16 v[88:103], v[128:131], v[8:11], v[24:39]
    v_mfma_f32_32x32x8_bf16 v[88:103], v[144:145], v[16:17], v[88:103]
    s_nop 7
    s_nop 3
    v_max3_f32 v169, v88, v89, v169
    v_max3_f32 v169, v90, v91, v169
    v_max3_f32 v169, v92, v93, v169
    v_max3_f32 v169, v94, v95, v169
    v_max3_f32 v169, v96, v97, v169
    v_max3_f32 v169, v98, v99, v169
    v_max3_f32 v169, v100, v101, v169
    v_max3_f32 v169, v102, v103, v169
    v_exp_f32 v88, v88
    v_exp_f32 v89, v89
    v_exp_f32 v90, v90
    v_exp_f32 v91, v91
    v_exp_f32 v92, v92
    v_exp_f32 v93, v93
    v_exp_f32 v94, v94
    v_exp_f32 v95, v95
    v_exp_f32 v96, v96
    v_exp_f32 v97, v97
    v_exp_f32 v98, v98
    v_exp_f32 v99, v99
    v_exp_f32 v100, v100
    v_exp_f32 v101, v101
    v_exp_f32 v102, v102
    v_exp_f32 v103, v103
    s_nop 0
    v_cvt_pk_bf16_f32 v120, v88, v89
    v_cvt_pk_bf16_f32 v121, v90, v91
    v_cvt_pk_bf16_f32 v122, v92, v93
    v_cvt_pk_bf16_f32 v123, v94, v95
    v_cvt_pk_bf16_f32 v124, v96, v97
    v_cvt_pk_bf16_f32 v125, v98, v99
    v_cvt_pk_bf16_f32 v126, v100, v101
    v_cvt_pk_bf16_f32 v127, v102, v103
    s_nop 1
    v_mfma_f32_32x32x16_bf16 v[56:71], v[148:151], v[120:123], v[56:71]
    v_mfma_f32_32x32x16_bf16 v[56:71], v[152:155], v[124:127], v[56:71]
    buffer_load_dwordx4 v[128:131], v2, s[4:7], s71 offen offset:1024 sc1
    s_add_u32 s73, s71, 6400
    s_mov_b64 exec, s[68:69]
    buffer_load_dwordx4 v[148:151], v165, s[4:7], s73 offen sc1
    buffer_load_dwordx4 v[152:155], v165, s[4:7], s73 offen offset:640 sc1
    s_mov_b64 exec, -1
    s_waitcnt vmcnt(0)
    v_mfma_f32_32x32x16_bf16 v[88:103], v[128:131], v[8:11], v[24:39]
    v_mfma_f32_32x32x8_bf16 v[88:103], v[144:145], v[18:19], v[88:103]
    s_nop 7
    s_nop 3
    v_max3_f32 v169, v88, v89, v169
    v_max3_f32 v169, v90, v91, v169
    v_max3_f32 v169, v92, v93, v169
    v_max3_f32 v169, v94, v95, v169
    v_max3_f32 v169, v96, v97, v169
    v_max3_f32 v169, v98, v99, v169
    v_max3_f32 v169, v100, v101, v169
    v_max3_f32 v169, v102, v103, v169
    v_exp_f32 v88, v88
    v_exp_f32 v89, v89
    v_exp_f32 v90, v90
    v_exp_f32 v91, v91
    v_exp_f32 v92, v92
    v_exp_f32 v93, v93
    v_exp_f32 v94, v94
    v_exp_f32 v95, v95
    v_exp_f32 v96, v96
    v_exp_f32 v97, v97
    v_exp_f32 v98, v98
    v_exp_f32 v99, v99
    v_exp_f32 v100, v100
    v_exp_f32 v101, v101
    v_exp_f32 v102, v102
    v_exp_f32 v103, v103
    s_nop 0
    v_cvt_pk_bf16_f32 v120, v88, v89
    v_cvt_pk_bf16_f32 v121, v90, v91
    v_cvt_pk_bf16_f32 v122, v92, v93
    v_cvt_pk_bf16_f32 v123, v94, v95
    v_cvt_pk_bf16_f32 v124, v96, v97
    v_cvt_pk_bf16_f32 v125, v98, v99
    v_cvt_pk_bf16_f32 v126, v100, v101
    v_cvt_pk_bf16_f32 v127, v102, v103
    s_nop 1
    v_mfma_f32_32x32x16_bf16 v[56:71], v[148:151], v[120:123], v[56:71]
    v_mfma_f32_32x32x16_bf16 v[56:71], v[152:155], v[124:127], v[56:71]
    buffer_load_dwordx4 v[128:131], v2, s[4:7], s71 offen offset:2048 sc1
    s_add_u32 s73, s71, 7680
    s_mov_b64 exec, s[68:69]
    buffer_load_dwordx4 v[148:151], v165, s[4:7], s73 offen sc1
    buffer_load_dwordx4 v[152:155], v165, s[4:7], s73 offen offset:640 sc1
    s_mov_b64 exec, -1
    s_waitcnt vmcnt(0)
    v_mfma_f32_32x32x16_bf16 v[88:103], v[128:131], v[8:11], v[24:39]
    v_mfma_f32_32x32x8_bf16 v[88:103], v[146:147], v[16:17], v[88:103]
    s_nop 7
    s_nop 3
    v_max3_f32 v169, v88, v89, v169
    v_max3_f32 v169, v90, v91, v169
    v_max3_f32 v169, v92, v93, v169
    v_max3_f32 v169, v94, v95, v169
    v_max3_f32 v169, v96, v97, v169
    v_max3_f32 v169, v98, v99, v169
    v_max3_f32 v169, v100, v101, v169
    v_max3_f32 v169, v102, v103, v169
    v_exp_f32 v88, v88
    v_exp_f32 v89, v89
    v_exp_f32 v90, v90
    v_exp_f32 v91, v91
    v_exp_f32 v92, v92
    v_exp_f32 v93, v93
    v_exp_f32 v94, v94
    v_exp_f32 v95, v95
    v_exp_f32 v96, v96
    v_exp_f32 v97, v97
    v_exp_f32 v98, v98
    v_exp_f32 v99, v99
    v_exp_f32 v100, v100
    v_exp_f32 v101, v101
    v_exp_f32 v102, v102
    v_exp_f32 v103, v103
    s_nop 0
    v_cvt_pk_bf16_f32 v120, v88, v89
    v_cvt_pk_bf16_f32 v121, v90, v91
    v_cvt_pk_bf16_f32 v122, v92, v93
    v_cvt_pk_bf16_f32 v123, v94, v95
    v_cvt_pk_bf16_f32 v124, v96, v97
    v_cvt_pk_bf16_f32 v125, v98, v99
    v_cvt_pk_bf16_f32 v126, v100, v101
    v_cvt_pk_bf16_f32 v127, v102, v103
    s_nop 1
    v_mfma_f32_32x32x16_bf16 v[56:71], v[148:151], v[120:123], v[56:71]
    v_mfma_f32_32x32x16_bf16 v[56:71], v[152:155], v[124:127], v[56:71]
    buffer_load_dwordx4 v[128:131], v2, s[4:7], s71 offen offset:3072 sc1
    s_add_u32 s73, s71, 8960
    s_mov_b64 exec, s[68:69]
    buffer_load_dwordx4 v[148:151], v165, s[4:7], s73 offen sc1
    buffer_load_dwordx4 v[152:155], v165, s[4:7], s73 offen offset:640 sc1
    s_mov_b64 exec, -1
    s_waitcnt vmcnt(0)
    v_mfma_f32_32x32x16_bf16 v[88:103], v[128:131], v[8:11], v[24:39]
    v_mfma_f32_32x32x8_bf16 v[88:103], v[146:147], v[18:19], v[88:103]
    s_nop 7
    s_nop 3
    v_max3_f32 v169, v88, v89, v169
    v_max3_f32 v169, v90, v91, v169
    v_max3_f32 v169, v92, v93, v169
    v_max3_f32 v169, v94, v95, v169
    v_max3_f32 v169, v96, v97, v169
    v_max3_f32 v169, v98, v99, v169
    v_max3_f32 v169, v100, v101, v169
    v_max3_f32 v169, v102, v103, v169
    v_exp_f32 v88, v88
    v_exp_f32 v89, v89
    v_exp_f32 v90, v90
    v_exp_f32 v91, v91
    v_exp_f32 v92, v92
    v_exp_f32 v93, v93
    v_exp_f32 v94, v94
    v_exp_f32 v95, v95
    v_exp_f32 v96, v96
    v_exp_f32 v97, v97
    v_exp_f32 v98, v98
    v_exp_f32 v99, v99
    v_exp_f32 v100, v100
    v_exp_f32 v101, v101
    v_exp_f32 v102, v102
    v_exp_f32 v103, v103
    s_nop 0
    v_cvt_pk_bf16_f32 v120, v88, v89
    v_cvt_pk_bf16_f32 v121, v90, v91
    v_cvt_pk_bf16_f32 v122, v92, v93
    v_cvt_pk_bf16_f32 v123, v94, v95
    v_cvt_pk_bf16_f32 v124, v96, v97
    v_cvt_pk_bf16_f32 v125, v98, v99
    v_cvt_pk_bf16_f32 v126, v100, v101
    v_cvt_pk_bf16_f32 v127, v102, v103
    s_nop 1
    v_mfma_f32_32x32x16_bf16 v[56:71], v[148:151], v[120:123], v[56:71]
    v_mfma_f32_32x32x16_bf16 v[56:71], v[152:155], v[124:127], v[56:71]
    s_add_u32 s71, s71, 10240
    s_add_u32 s72, s72, 1
    s_cmp_lt_u32 s72, 16
    s_cbranch_scc1 L_p2_fb_loop
    s_nop 7
    s_nop 3
    s_cmp_eq_u32 s70, 1
    s_cbranch_scc1 L_p2_fb_next
    v_mov_b32 v170, v169
    s_nop 1
    v_permlane32_swap_b32 v169, v170
    v_max_f32 v169, v169, v170
    v_sub_f32 v24, 0, v169
    v_mov_b32 v25, v24
    v_mov_b32 v26, v24
    v_mov_b32 v27, v24
    v_mov_b32 v28, v24
    v_mov_b32 v29, v24
    v_mov_b32 v30, v24
    v_mov_b32 v31, v24
    v_mov_b32 v32, v24
    v_mov_b32 v33, v24
    v_mov_b32 v34, v24
    v_mov_b32 v35, v24
    v_mov_b32 v36, v24
    v_mov_b32 v37, v24
    v_mov_b32 v38, v24
    v_mov_b32 v39, v24
    s_mov_b32 s70, 1
    s_branch L_p2_fb_pass
L_p2_fb_next:
    v_swap_b32 v8, v12
    v_swap_b32 v16, v20
    v_swap_b32 v9, v13
    v_swap_b32 v17, v21
    v_swap_b32 v10, v14
    v_swap_b32 v18, v22
    v_swap_b32 v11, v15
    v_swap_b32 v19, v23
    v_swap_b32 v56, v72
    v_swap_b32 v57, v73
    v_swap_b32 v58, v74
    v_swap_b32 v59, v75
    v_swap_b32 v60, v76
    v_swap_b32 v61, v77
    v_swap_b32 v62, v78
    v_swap_b32 v63, v79
    v_swap_b32 v64, v80
    v_swap_b32 v65, v81
    v_swap_b32 v66, v82
    s_add_u32 s32, s32, 1
    s_cmp_lt_u32 s32, 2
    s_cbranch_scc1 L_p2_fb_tile
    s_branch L_p2_final
L_code_end:
.section .rodata,"a"
.p2align 6
.amdhsa_kernel adaLN_cond__grouped_kv_mqa__mixer_channel_mlp__prompt_kernel
  .amdhsa_next_free_vgpr 256
  .amdhsa_next_free_sgpr 80
  .amdhsa_accum_offset 256
  .amdhsa_group_segment_fixed_size 0
  .amdhsa_kernarg_size 120
  .amdhsa_user_sgpr_count 2
  .amdhsa_user_sgpr_kernarg_segment_ptr 1
  .amdhsa_system_sgpr_workgroup_id_x 1
.end_amdhsa_kernel
```
